```python
import torch

def _softmax(x, axis=-1):
    return torch.softmax(x, dim=axis)
def _gelu(x):
    return torch.nn.functional.gelu(x, approximate="tanh")
def _silu(x):
    return torch.nn.functional.silu(x)
def _sigmoid(x):
    return torch.sigmoid(x)
def _layernorm(x, axis=-1, eps=1e-5):
    m = x.mean(dim=axis, keepdim=True)
    v = x.var(dim=axis, keepdim=True, unbiased=False)
    return (x - m) / torch.sqrt(v + eps)
def _scatter_add(tgt, idx, src, axis=0):
    return tgt.clone().index_add_(axis, idx, src)
def _segment_sum(src, seg, n):
    out = torch.zeros((n,) + src.shape[1:], dtype=src.dtype)
    return out.index_add_(0, seg, src)
def _pad(x, pw):
    flat = tuple(v for pair in reversed(pw) for v in pair)
    return torch.nn.functional.pad(x, flat)

kernel_name = 'concat_heads__linear_attn_block__ssm_conv_s5__prompt'

def setup_inputs():

    _w = (lambda a: (lambda t: t.to(torch.bfloat16) if t.is_floating_point() else t)(torch.as_tensor(a)))
    def _A_setup():
        B, S, D = 1, 2048, 640
        return {
            "x": _w((lambda *s: torch.randn(*s, dtype=torch.bfloat16) * 0.05)(B, S, D)),
            "wqkv": _w((lambda *s: torch.randn(*s, dtype=torch.bfloat16) * 0.4)(D, 3 * D)),
            "wo": _w((lambda *s: torch.randn(*s, dtype=torch.bfloat16) * 0.05)(D, D)),
        }
    _A_in = _A_setup()

    def _B_setup():
        B, S, D = 1, 2048, 640
        P = D
        Lambda_re = -0.5 * (lambda _x: torch.exp(torch.as_tensor(_x)))((lambda *s: torch.randn(*s, dtype=torch.bfloat16) * 0.2)(P))
        Lambda_im = (lambda *s: torch.randn(*s, dtype=torch.bfloat16) * 0.8)(P) * 1.0
        B_re = (lambda *s: torch.randn(*s, dtype=torch.bfloat16) * 0.4)(P, D) * (D ** -0.5)
        B_im = (lambda *s: torch.randn(*s, dtype=torch.bfloat16) * 0.2)(P, D) * (D ** -0.5)
        C_re = (lambda *s: torch.randn(*s, dtype=torch.bfloat16) * 0.2)(D, P) * (P ** -0.5)
        C_im = (lambda *s: torch.randn(*s, dtype=torch.bfloat16) * 0.4)(D, P) * (P ** -0.5)
        log_dt = (lambda *s: torch.randn(*s, dtype=torch.bfloat16) * 0.2)(P) * 0.3 - 2.0
        Dskip = (lambda *s: torch.randn(*s, dtype=torch.bfloat16) * 0.05)(D)
        return {
            "x": _w((lambda *s: torch.randn(*s, dtype=torch.bfloat16) * 0.05)(B, S, D)),
            "Lambda_re": _w(Lambda_re),
            "Lambda_im": _w(Lambda_im),
            "B_re": _w(B_re),
            "B_im": _w(B_im),
            "C_re": _w(C_re),
            "C_im": _w(C_im),
            "log_dt": _w(log_dt),
            "Dskip": _w(Dskip),
        }
    _B_in = _B_setup()

    return {
        "A_x": _A_in["x"],
        "A_wqkv": _A_in["wqkv"],
        "A_wo": _A_in["wo"],
        "B_x": _B_in["x"],
        "B_Lambda_re": _B_in["Lambda_re"],
        "B_Lambda_im": _B_in["Lambda_im"],
        "B_B_re": _B_in["B_re"],
        "B_B_im": _B_in["B_im"],
        "B_C_re": _B_in["C_re"],
        "B_C_im": _B_in["C_im"],
        "B_log_dt": _B_in["log_dt"],
        "B_Dskip": _B_in["Dskip"],
    }

def reference(A_x, A_wqkv, A_wo, B_x, B_Lambda_re, B_Lambda_im, B_B_re, B_B_im, B_C_re, B_C_im, B_log_dt, B_Dskip):
    def _A_ref(x, wqkv, wo):
        B, S, D = x.shape
        H = 32; Dh = D // H
        qkv = (lambda x, *d: x.permute(*d))((x @ wqkv).reshape(B, S, 3, H, Dh), 2, 0, 3, 1, 4)
        q, k, v = qkv[0], qkv[1], qkv[2]
        phi = lambda t: torch.where(t > 0, t + 1, torch.exp(t)) + 1e-6
        pq, pk = phi(q), phi(k)
        kv = torch.einsum("bhsd,bhse->bhde", pk, v)
        z = torch.einsum("bhsd->bhd", pk)
        num = torch.einsum("bhqd,bhde->bhqe", pq, kv)
        den = torch.einsum("bhqd,bhd->bhq", pq, z)[..., None] + 1e-6
        o = num / den
        return (lambda x, *d: x.permute(*d))(o, 0, 2, 1, 3).reshape(B, S, D) @ wo

    def _B_ref(x, Lambda_re, Lambda_im, B_re, B_im, C_re, C_im, log_dt, Dskip):
        Bsz, L, H = x.shape
        Lam = Lambda_re + 1j * Lambda_im
        Bmat = B_re + 1j * B_im
        Cmat = C_re + 1j * C_im
        dt = torch.exp(log_dt)
        Lam_bar = torch.exp(dt * Lam)
        B_bar = ((Lam_bar - 1.0) / Lam)[:, None] * Bmat
        Bu = torch.einsum("bld,pd->blp", x + 0j, B_bar)
        h = torch.zeros_like(Bu[:, 0, :])
        hs = []
        for t in range(L):
            h = Lam_bar[None, :] * h + Bu[:, t, :]
            hs.append(h)
        hseq = torch.stack(hs, 1)
        y = 2.0 * torch.einsum("blp,dp->bld", hseq, Cmat).real + x * Dskip[None, None, :]
        return y

    a = _A_ref(A_x, A_wqkv, A_wo)
    b = _B_ref(B_x, B_Lambda_re, B_Lambda_im, B_B_re, B_B_im, B_C_re, B_C_im, B_log_dt, B_Dskip)
    return torch.concatenate([a, b], axis=-1)
```

```asm
; @launch grid=(256,1,1) block=(512,1,1) lds=163840
.amdgcn_target "amdgcn-amd-amdhsa--gfx950"
.text
.globl concat_heads__linear_attn_block__ssm_conv_s5__prompt_kernel
.p2align 8
.type concat_heads__linear_attn_block__ssm_conv_s5__prompt_kernel,@function
concat_heads__linear_attn_block__ssm_conv_s5__prompt_kernel:
    s_cmp_ge_u32 s2, 256
    s_cbranch_scc1 L_exit
    s_load_dwordx16 s[4:19], s[0:1], 0
    s_load_dwordx8 s[20:27], s[0:1], 64
    s_load_dwordx4 s[28:31], s[0:1], 96
    s_load_dwordx2 s[32:33], s[0:1], 112
    v_lshrrev_b32 v1, 6, v0
    v_and_b32 v0, 63, v0
    v_readfirstlane_b32 s34, v1
    s_lshr_b32 s60, s2, 3
    s_lshr_b32 s54, s60, 3
    s_and_b32 s53, s60, 7
    s_and_b32 s35, s2, 1
    s_bfe_u32 s59, s2, 0x20001
    s_lshl_b32 s52, s59, 2
    s_add_u32 s52, s52, s54
    s_getreg_b32 s76, hwreg(HW_REG_XCC_ID, 0, 4)
    s_and_b32 s55, s34, 3
    s_cmp_eq_u32 s35, 1
    s_cbranch_scc1 L_B
    s_cmp_ge_u32 s34, 4
    s_cbranch_scc1 L_AL
    s_branch L_AC
L_exit:
    s_endpgm
L_B:
    s_cmp_ge_u32 s34, 4
    s_cbranch_scc1 L_BL
    s_branch L_BC
L_AL:
    s_lshl_b32 s59, s52, 2
    s_add_u32 s59, s59, s55
    s_mul_i32 s59, s59, 40960
    v_lshrrev_b32 v250, 4, v0
    v_and_b32 v251, 7, v0
    v_xor_b32 v250, v250, v251
    v_lshlrev_b32 v250, 4, v250
    v_lshrrev_b32 v251, 3, v0
    v_mul_u32_u24 v251, 1280, v251
    v_add_u32 v251, s59, v251
    v_xor_b32 v252, 64, v250
    v_add_u32 v250, v250, v251
    v_add_u32 v252, v252, v251
    v_add_u32 v24, 0, v250
    v_add_u32 v25, 10240, v252
    v_add_u32 v26, 20480, v250
    v_add_u32 v27, 30720, v252
    s_add_u32 s57, s54, s53
    s_and_b32 s57, s57, 1
    s_mul_i32 s57, s57, 5
    s_lshr_b32 s59, s52, 2
    s_add_u32 s57, s57, s59
    s_cmp_ge_u32 s57, 10
    s_cselect_b32 s59, 10, 0
    s_sub_u32 s57, s57, s59
    s_lshr_b32 s61, s53, 1
    s_lshr_b32 s62, s54, 1
    s_mov_b32 s71, s61
    s_add_u32 s59, s71, 0
    s_and_b32 s59, s59, 3
    s_lshl_b32 s94, s55, 2
    s_add_u32 s94, s94, s59
    s_lshl_b32 s94, s94, 10
    s_bitcmp1_b32 s59, 0
    s_cselect_b64 vcc, -1, 0
    v_cndmask_b32 v1, v24, v25, vcc
    s_lshr_b32 s59, s59, 1
    s_mul_i32 s59, s59, 20480
    v_add_u32 v1, s59, v1
    s_mul_i32 s73, s55, 7680
    s_add_u32 s73, s73, 16384
    s_mov_b32 s58, 0
    s_lshl_b32 s72, s62, 8
    s_lshl_b32 s59, s62, 12
    s_add_u32 s98, s73, s59
    s_xor_b32 s59, s59, 4096
    s_add_u32 s99, s73, s59
    s_cmp_eq_u32 s62, 0
    s_cselect_b32 s100, -1, 0
    s_cselect_b32 s101, 0, -1
    s_lshr_b32 s59, s55, 1
    s_lshl_b32 s59, s59, 5
    s_and_b32 s60, s55, 1
    s_lshl_b32 s60, s60, 2
    s_add_u32 s59, s59, s60
    s_mul_i32 s59, s59, 3840
    s_mul_i32 s60, s53, 160
    s_add_u32 s64, s59, s60
    s_movk_i32 s68, 3840
    s_movk_i32 s63, 1120
    s_lshl_b32 s69, s57, 7
    s_mul_i32 s93, s57, 245760
    s_mov_b32 s61, s58
    s_add_u32 s62, s58, s98
    s_add_u32 s70, s58, s99
    v_add_u32 v250, 0, v0
    v_xor_b32 v250, s72, v250
    v_mul_u32_u24 v251, 2185, v250
    v_lshrrev_b32 v251, 16, v251
    v_mul_u32_u24 v252, 30, v251
    v_sub_u32 v252, v250, v252
    v_mul_u32_u24 v253, 26, v252
    v_lshrrev_b32 v253, 8, v253
    v_and_b32 v250, -4, v251
    v_add_u32 v251, v251, v250
    v_lshlrev_b32 v252, 4, v252
    v_mad_u32_u24 v252, v253, s63, v252
    v_mad_u32_u24 v252, v251, s68, v252
    v_add_u32 v5, s64, v252
    s_waitcnt lgkmcnt(0)
    s_mov_b32 s36, s4
    s_mov_b32 s37, s5
    s_mov_b32 s38, 2621440
    s_mov_b32 s39, 0x20000
    s_mov_b32 s40, s6
    s_mov_b32 s41, s7
    s_mov_b32 s42, 2457600
    s_mov_b32 s43, 0x20000
    s_add_u32 m0, s61, s94
    s_nop 0
    buffer_load_dwordx4 v1, s[36:39], s69 offen lds
    s_add_u32 m0, s62, 0
    s_nop 0
    buffer_load_dwordx4 v5, s[40:43], s93 offen lds
    v_add_u32 v250, 64, v0
    v_xor_b32 v250, s72, v250
    v_mul_u32_u24 v251, 2185, v250
    v_lshrrev_b32 v251, 16, v251
    v_mul_u32_u24 v252, 30, v251
    v_sub_u32 v252, v250, v252
    v_mul_u32_u24 v253, 26, v252
    v_lshrrev_b32 v253, 8, v253
    v_and_b32 v250, -4, v251
    v_add_u32 v251, v251, v250
    v_lshlrev_b32 v252, 4, v252
    v_mad_u32_u24 v252, v253, s63, v252
    v_mad_u32_u24 v252, v251, s68, v252
    v_add_u32 v6, s64, v252
    s_add_u32 m0, s62, 1024
    s_nop 0
    buffer_load_dwordx4 v6, s[40:43], s93 offen lds
    v_add_u32 v250, 128, v0
    v_xor_b32 v250, s72, v250
    v_mul_u32_u24 v251, 2185, v250
    v_lshrrev_b32 v251, 16, v251
    v_mul_u32_u24 v252, 30, v251
    v_sub_u32 v252, v250, v252
    v_mul_u32_u24 v253, 26, v252
    v_lshrrev_b32 v253, 8, v253
    v_and_b32 v250, -4, v251
    v_add_u32 v251, v251, v250
    v_lshlrev_b32 v252, 4, v252
    v_mad_u32_u24 v252, v253, s63, v252
    v_mad_u32_u24 v252, v251, s68, v252
    v_add_u32 v7, s64, v252
    s_add_u32 m0, s62, 2048
    s_nop 0
    buffer_load_dwordx4 v7, s[40:43], s93 offen lds
    v_add_u32 v250, 192, v0
    v_xor_b32 v250, s72, v250
    v_mul_u32_u24 v251, 2185, v250
    v_lshrrev_b32 v251, 16, v251
    v_mul_u32_u24 v252, 30, v251
    v_sub_u32 v252, v250, v252
    v_mul_u32_u24 v253, 26, v252
    v_lshrrev_b32 v253, 8, v253
    v_and_b32 v250, -4, v251
    v_add_u32 v251, v251, v250
    v_lshlrev_b32 v252, 4, v252
    v_mad_u32_u24 v252, v253, s63, v252
    v_mad_u32_u24 v252, v251, s68, v252
    v_add_u32 v8, s64, v252
    s_mov_b32 exec_hi, s100
    s_add_u32 m0, s62, 3072
    s_nop 0
    buffer_load_dwordx4 v8, s[40:43], s93 offen lds
    s_mov_b64 exec, -1
    s_add_u32 s57, s57, 1
    s_cmp_eq_u32 s57, 10
    s_cselect_b32 s57, 0, s57
    s_add_u32 s58, s58, 47104
    s_cmp_eq_u32 s58, 141312
    s_cselect_b32 s58, 0, s58
    v_add_u32 v250, 256, v0
    v_xor_b32 v250, s72, v250
    v_mul_u32_u24 v251, 2185, v250
    v_lshrrev_b32 v251, 16, v251
    v_mul_u32_u24 v252, 30, v251
    v_sub_u32 v252, v250, v252
    v_mul_u32_u24 v253, 26, v252
    v_lshrrev_b32 v253, 8, v253
    v_and_b32 v250, -4, v251
    v_add_u32 v251, v251, v250
    v_lshlrev_b32 v252, 4, v252
    v_mad_u32_u24 v252, v253, s63, v252
    v_mad_u32_u24 v252, v251, s68, v252
    v_add_u32 v9, s64, v252
    s_add_u32 m0, s70, 0
    s_nop 0
    buffer_load_dwordx4 v9, s[40:43], s93 offen lds
    v_add_u32 v250, 320, v0
    v_xor_b32 v250, s72, v250
    v_mul_u32_u24 v251, 2185, v250
    v_lshrrev_b32 v251, 16, v251
    v_mul_u32_u24 v252, 30, v251
    v_sub_u32 v252, v250, v252
    v_mul_u32_u24 v253, 26, v252
    v_lshrrev_b32 v253, 8, v253
    v_and_b32 v250, -4, v251
    v_add_u32 v251, v251, v250
    v_lshlrev_b32 v252, 4, v252
    v_mad_u32_u24 v252, v253, s63, v252
    v_mad_u32_u24 v252, v251, s68, v252
    v_add_u32 v10, s64, v252
    s_add_u32 m0, s70, 1024
    s_nop 0
    buffer_load_dwordx4 v10, s[40:43], s93 offen lds
    v_add_u32 v250, 384, v0
    v_xor_b32 v250, s72, v250
    v_mul_u32_u24 v251, 2185, v250
    v_lshrrev_b32 v251, 16, v251
    v_mul_u32_u24 v252, 30, v251
    v_sub_u32 v252, v250, v252
    v_mul_u32_u24 v253, 26, v252
    v_lshrrev_b32 v253, 8, v253
    v_and_b32 v250, -4, v251
    v_add_u32 v251, v251, v250
    v_lshlrev_b32 v252, 4, v252
    v_mad_u32_u24 v252, v253, s63, v252
    v_mad_u32_u24 v252, v251, s68, v252
    v_add_u32 v11, s64, v252
    s_add_u32 m0, s70, 2048
    s_nop 0
    buffer_load_dwordx4 v11, s[40:43], s93 offen lds
    v_add_u32 v250, 448, v0
    v_xor_b32 v250, s72, v250
    v_mul_u32_u24 v251, 2185, v250
    v_lshrrev_b32 v251, 16, v251
    v_mul_u32_u24 v252, 30, v251
    v_sub_u32 v252, v250, v252
    v_mul_u32_u24 v253, 26, v252
    v_lshrrev_b32 v253, 8, v253
    v_and_b32 v250, -4, v251
    v_add_u32 v251, v251, v250
    v_lshlrev_b32 v252, 4, v252
    v_mad_u32_u24 v252, v253, s63, v252
    v_mad_u32_u24 v252, v251, s68, v252
    v_add_u32 v12, s64, v252
    s_mov_b32 exec_hi, s101
    s_add_u32 m0, s70, 3072
    s_nop 0
    buffer_load_dwordx4 v12, s[40:43], s93 offen lds
    s_mov_b64 exec, -1
    s_add_u32 s59, s71, 1
    s_and_b32 s59, s59, 3
    s_lshl_b32 s95, s55, 2
    s_add_u32 s95, s95, s59
    s_lshl_b32 s95, s95, 10
    s_bitcmp1_b32 s59, 0
    s_cselect_b64 vcc, -1, 0
    v_cndmask_b32 v2, v24, v25, vcc
    s_lshr_b32 s59, s59, 1
    s_mul_i32 s59, s59, 20480
    v_add_u32 v2, s59, v2
    s_add_u32 m0, s61, s95
    s_nop 0
    buffer_load_dwordx4 v2, s[36:39], s69 offen lds
    s_add_u32 s59, s71, 2
    s_and_b32 s59, s59, 3
    s_lshl_b32 s96, s55, 2
    s_add_u32 s96, s96, s59
    s_lshl_b32 s96, s96, 10
    s_bitcmp1_b32 s59, 0
    s_cselect_b64 vcc, -1, 0
    v_cndmask_b32 v3, v24, v25, vcc
    s_lshr_b32 s59, s59, 1
    s_mul_i32 s59, s59, 20480
    v_add_u32 v3, s59, v3
    s_add_u32 m0, s61, s96
    s_nop 0
    buffer_load_dwordx4 v3, s[36:39], s69 offen lds
    s_add_u32 s59, s71, 3
    s_and_b32 s59, s59, 3
    s_lshl_b32 s97, s55, 2
    s_add_u32 s97, s97, s59
    s_lshl_b32 s97, s97, 10
    s_bitcmp1_b32 s59, 0
    s_cselect_b64 vcc, -1, 0
    v_cndmask_b32 v4, v24, v25, vcc
    s_lshr_b32 s59, s59, 1
    s_mul_i32 s59, s59, 20480
    v_add_u32 v4, s59, v4
    s_add_u32 m0, s61, s97
    s_nop 0
    buffer_load_dwordx4 v4, s[36:39], s69 offen lds
    s_lshl_b32 s59, s35, 8
    s_load_dword s56, s[32:33], s59
    s_mov_b32 s44, s8
    s_mov_b32 s45, s9
    s_mov_b32 s46, 819200
    s_mov_b32 s47, 0x20000
    s_mov_b32 s48, s32
    s_mov_b32 s49, s33
    s_mov_b32 s50, 268435456
    s_mov_b32 s51, 0x20000
    s_mul_i32 s59, s53, 160
    v_add_u32 v250, 0, v0
    v_mul_u32_u24 v251, 6554, v250
    v_lshrrev_b32 v251, 16, v251
    v_mad_i32_i24 v252, v251, -10, v250
    v_mul_u32_u24 v251, 1280, v251
    v_lshl_add_u32 v251, v252, 4, v251
    v_add_u32 v13, s59, v251
    v_add_u32 v250, 64, v0
    v_mul_u32_u24 v251, 6554, v250
    v_lshrrev_b32 v251, 16, v251
    v_mad_i32_i24 v252, v251, -10, v250
    v_mul_u32_u24 v251, 1280, v251
    v_lshl_add_u32 v251, v252, 4, v251
    v_add_u32 v14, s59, v251
    v_add_u32 v250, 128, v0
    v_mul_u32_u24 v251, 6554, v250
    v_lshrrev_b32 v251, 16, v251
    v_mad_i32_i24 v252, v251, -10, v250
    v_mul_u32_u24 v251, 1280, v251
    v_lshl_add_u32 v251, v252, 4, v251
    v_add_u32 v15, s59, v251
    v_add_u32 v250, 192, v0
    v_mul_u32_u24 v251, 6554, v250
    v_lshrrev_b32 v251, 16, v251
    v_mad_i32_i24 v252, v251, -10, v250
    v_mul_u32_u24 v251, 1280, v251
    v_lshl_add_u32 v251, v252, 4, v251
    v_add_u32 v16, s59, v251
    v_add_u32 v250, 256, v0
    v_mul_u32_u24 v251, 6554, v250
    v_lshrrev_b32 v251, 16, v251
    v_mad_i32_i24 v252, v251, -10, v250
    v_mul_u32_u24 v251, 1280, v251
    v_lshl_add_u32 v251, v252, 4, v251
    v_add_u32 v17, s59, v251
    s_mul_i32 s90, s53, 71680
    s_add_u32 s90, s90, 196608
    s_mul_i32 s91, s52, 4480
    s_add_u32 s91, s91, s90
    v_and_b32 v250, 15, v0
    v_lshrrev_b32 v251, 4, v0
    s_mul_i32 s59, s54, 70
    s_lshl_b32 s60, s55, 4
    s_add_u32 s60, s60, s59
    v_add_u32 v252, s60, v250
    v_mul_u32_u24 v253, 4480, v251
    v_lshl_add_u32 v204, v252, 4, v253
    s_lshl_b32 s61, s55, 1
    s_min_u32 s61, s61, 4
    s_add_u32 s61, s61, 64
    s_add_u32 s64, s61, s59
    v_and_b32 v253, 1, v0
    v_add_u32 v254, s64, v253
    v_bfe_u32 v253, v0, 1, 4
    v_mul_u32_u24 v253, 4480, v253
    v_lshl_add_u32 v207, v254, 4, v253
    s_mov_b64 vcc, 0xffff
    v_cndmask_b32 v252, v254, v252, vcc
    v_mul_u32_u24 v253, 12, v252
    v_add_u32 v201, 160000, v253
    v_subrev_u32 v252, s59, v252
    v_lshlrev_b32 v200, 4, v252
    s_lshl_b32 s60, s55, 6
    v_add_u32 v252, s60, v0
    v_mul_u32_u24 v253, 937, v252
    v_lshrrev_b32 v253, 16, v253
    v_mul_u32_u24 v254, 70, v253
    v_sub_u32 v254, v252, v254
    s_add_u32 s60, s54, 1
    v_add_u32 v253, s60, v253
    v_and_b32 v253, 3, v253
    v_mul_u32_u24 v252, 1152, v253
    v_lshl_add_u32 v202, v254, 4, v252
    v_mul_u32_u24 v253, 70, v253
    v_add_u32 v253, v253, v254
    v_mul_u32_u24 v253, 12, v253
    v_add_u32 v203, 160000, v253
    s_lshr_b32 s59, s52, 2
    s_lshl_b32 s59, s59, 3
    s_add_u32 s59, s59, s53
    s_mul_i32 s86, s59, 4608
    s_add_u32 s86, s86, 786432
    s_lshl_b32 s87, s59, 7
    s_add_u32 s87, s87, 983040
    s_lshl_b32 s69, s57, 7
    s_mul_i32 s93, s57, 245760
    s_mov_b32 s61, s58
    s_add_u32 s62, s58, s98
    s_add_u32 s70, s58, s99
    s_add_u32 m0, s61, s94
    s_nop 0
    buffer_load_dwordx4 v1, s[36:39], s69 offen lds
    s_add_u32 m0, s62, 0
    s_nop 0
    buffer_load_dwordx4 v5, s[40:43], s93 offen lds
    s_add_u32 m0, s62, 1024
    s_nop 0
    buffer_load_dwordx4 v6, s[40:43], s93 offen lds
    s_add_u32 m0, s62, 2048
    s_nop 0
    buffer_load_dwordx4 v7, s[40:43], s93 offen lds
    s_mov_b32 exec_hi, s100
    s_add_u32 m0, s62, 3072
    s_nop 0
    buffer_load_dwordx4 v8, s[40:43], s93 offen lds
    s_mov_b64 exec, -1
    s_add_u32 s57, s57, 1
    s_cmp_eq_u32 s57, 10
    s_cselect_b32 s57, 0, s57
    s_add_u32 s58, s58, 47104
    s_cmp_eq_u32 s58, 141312
    s_cselect_b32 s58, 0, s58
    s_waitcnt vmcnt(5) lgkmcnt(0)
    s_mul_i32 s56, s56, 1664525
    s_add_u32 s56, s56, 1013904223
    s_max_u32 s56, s56, 16
    s_barrier
    s_cmp_lg_u32 s55, 1
    s_cbranch_scc1 L_x2_1
    s_mul_i32 s59, s54, 1152
    s_add_u32 s59, s59, s86
    v_lshlrev_b32 v252, 7, v0
    s_mov_b64 exec, 0x1ff
    buffer_load_dword v255, v252, s[48:51], s59 offen sc1
    s_xor_b32 s59, s56, s76
    v_mov_b32 v253, s59
    s_lshl_b32 s59, s54, 2
    s_add_u32 s59, s59, s87
    s_mov_b64 exec, 1
    buffer_store_dword v253, v252, s[48:51], s59 offen sc1
    s_mov_b64 exec, -1
L_x2_1:
    s_add_u32 m0, s70, 0
    s_nop 0
    buffer_load_dwordx4 v9, s[40:43], s93 offen lds
    s_add_u32 m0, s70, 1024
    s_nop 0
    buffer_load_dwordx4 v10, s[40:43], s93 offen lds
    s_add_u32 m0, s70, 2048
    s_nop 0
    buffer_load_dwordx4 v11, s[40:43], s93 offen lds
    s_mov_b32 exec_hi, s101
    s_add_u32 m0, s70, 3072
    s_nop 0
    buffer_load_dwordx4 v12, s[40:43], s93 offen lds
    s_mov_b64 exec, -1
    s_add_u32 m0, s61, s95
    s_nop 0
    buffer_load_dwordx4 v2, s[36:39], s69 offen lds
    s_add_u32 m0, s61, s96
    s_nop 0
    buffer_load_dwordx4 v3, s[36:39], s69 offen lds
    s_add_u32 m0, s61, s97
    s_nop 0
    buffer_load_dwordx4 v4, s[36:39], s69 offen lds
    s_mov_b32 s65, 2
L_ld_2:
    s_lshl_b32 s69, s57, 7
    s_mul_i32 s93, s57, 245760
    s_mov_b32 s61, s58
    s_add_u32 s62, s58, s98
    s_add_u32 s70, s58, s99
    s_add_u32 m0, s61, s94
    s_nop 0
    buffer_load_dwordx4 v1, s[36:39], s69 offen lds
    s_add_u32 m0, s62, 0
    s_nop 0
    buffer_load_dwordx4 v5, s[40:43], s93 offen lds
    s_add_u32 m0, s62, 1024
    s_nop 0
    buffer_load_dwordx4 v6, s[40:43], s93 offen lds
    s_add_u32 m0, s62, 2048
    s_nop 0
    buffer_load_dwordx4 v7, s[40:43], s93 offen lds
    s_mov_b32 exec_hi, s100
    s_add_u32 m0, s62, 3072
    s_nop 0
    buffer_load_dwordx4 v8, s[40:43], s93 offen lds
    s_mov_b64 exec, -1
    s_add_u32 s57, s57, 1
    s_cmp_eq_u32 s57, 10
    s_cselect_b32 s57, 0, s57
    s_add_u32 s58, s58, 47104
    s_cmp_eq_u32 s58, 141312
    s_cselect_b32 s58, 0, s58
    s_add_u32 s65, s65, 1
    s_waitcnt vmcnt(5)
    s_barrier
    s_add_u32 m0, s70, 0
    s_nop 0
    buffer_load_dwordx4 v9, s[40:43], s93 offen lds
    s_add_u32 m0, s70, 1024
    s_nop 0
    buffer_load_dwordx4 v10, s[40:43], s93 offen lds
    s_add_u32 m0, s70, 2048
    s_nop 0
    buffer_load_dwordx4 v11, s[40:43], s93 offen lds
    s_mov_b32 exec_hi, s101
    s_add_u32 m0, s70, 3072
    s_nop 0
    buffer_load_dwordx4 v12, s[40:43], s93 offen lds
    s_mov_b64 exec, -1
    s_add_u32 m0, s61, s95
    s_nop 0
    buffer_load_dwordx4 v2, s[36:39], s69 offen lds
    s_add_u32 m0, s61, s96
    s_nop 0
    buffer_load_dwordx4 v3, s[36:39], s69 offen lds
    s_add_u32 m0, s61, s97
    s_nop 0
    buffer_load_dwordx4 v4, s[36:39], s69 offen lds
    s_cmp_lt_u32 s65, 10
    s_cbranch_scc1 L_ld_2
    s_lshl_b32 s59, s54, 2
    s_add_u32 s59, s59, s55
    s_mul_i32 s59, s59, 10240
    s_mul_i32 s60, s53, 160
    s_add_u32 s59, s59, s60
    v_lshrrev_b32 v250, 1, v0
    v_mul_u32_u24 v250, 1280, v250
    v_and_b32 v251, 1, v0
    v_lshl_add_u32 v250, v251, 7, v250
    s_mov_b64 exec, 0xffff
    buffer_load_dword v254, v250, s[44:47], s59 offen
    s_mov_b64 exec, -1
    s_waitcnt vmcnt(1)
    s_barrier
    s_cmp_lg_u32 s55, 3
    s_cbranch_scc1 L_nox_3
    s_lshl_b32 s59, s35, 4
    s_add_u32 s59, s59, s52
    s_lshl_b32 s59, s59, 10
    s_add_u32 s59, s59, 4096
    s_lshl_b32 s60, s53, 2
    s_add_u32 s59, s59, s60
    s_xor_b32 s60, s56, s76
    v_mov_b32 v250, s60
    v_mov_b32 v251, 512
    s_mov_b64 exec, 1
    buffer_store_dword v250, v251, s[48:51], s59 offen sc1
    s_mov_b64 exec, -1
L_nox_3:
    s_mov_b32 s65, 0
L_wo_4:
    s_add_u32 s61, s65, s54
    s_and_b32 s61, s61, 3
    s_add_u32 s61, s61, 1
    s_cmp_eq_u32 s65, 4
    s_cselect_b32 s61, 0, s61
    s_lshl_b32 s61, s61, 2
    s_add_u32 s61, s61, s55
    s_mul_i32 s59, s61, 40960
    s_mul_i32 s60, s61, 5120
    s_add_u32 s60, s60, 30720
    s_add_u32 m0, s60, 0
    s_nop 0
    buffer_load_dwordx4 v13, s[44:47], s59 offen lds
    s_add_u32 m0, s60, 1024
    s_nop 0
    buffer_load_dwordx4 v14, s[44:47], s59 offen lds
    s_add_u32 m0, s60, 2048
    s_nop 0
    buffer_load_dwordx4 v15, s[44:47], s59 offen lds
    s_add_u32 m0, s60, 3072
    s_nop 0
    buffer_load_dwordx4 v16, s[44:47], s59 offen lds
    s_add_u32 m0, s60, 4096
    s_nop 0
    buffer_load_dwordx4 v17, s[44:47], s59 offen lds
    s_add_u32 s65, s65, 1
    s_cmp_lt_u32 s65, 2
    s_cbranch_scc1 L_wo_4
    s_barrier
    s_mov_b32 s65, 2
L_wo_5:
    s_add_u32 s61, s65, s54
    s_and_b32 s61, s61, 3
    s_add_u32 s61, s61, 1
    s_cmp_eq_u32 s65, 4
    s_cselect_b32 s61, 0, s61
    s_lshl_b32 s61, s61, 2
    s_add_u32 s61, s61, s55
    s_mul_i32 s59, s61, 40960
    s_mul_i32 s60, s61, 5120
    s_add_u32 s60, s60, 30720
    s_add_u32 m0, s60, 0
    s_nop 0
    buffer_load_dwordx4 v13, s[44:47], s59 offen lds
    s_add_u32 m0, s60, 1024
    s_nop 0
    buffer_load_dwordx4 v14, s[44:47], s59 offen lds
    s_add_u32 m0, s60, 2048
    s_nop 0
    buffer_load_dwordx4 v15, s[44:47], s59 offen lds
    s_add_u32 m0, s60, 3072
    s_nop 0
    buffer_load_dwordx4 v16, s[44:47], s59 offen lds
    s_add_u32 m0, s60, 4096
    s_nop 0
    buffer_load_dwordx4 v17, s[44:47], s59 offen lds
    s_add_u32 s65, s65, 1
    s_cmp_lt_u32 s65, 4
    s_cbranch_scc1 L_wo_5
    v_lshlrev_b32 v250, 2, v0
    s_mov_b64 exec, 15
    s_mov_b32 s66, 0
L_x2p_8:
    buffer_load_dword v251, v250, s[48:51], s87 offen sc1
    s_waitcnt vmcnt(0)
    v_xor_b32 v251, s56, v251
    v_cmp_le_u32 vcc, 16, v251
    s_cbranch_vccz L_x2o_9
    s_add_u32 s66, s66, 1
    s_cmp_lt_u32 s66, 200000
    s_cbranch_scc1 L_x2p_8
L_x2o_9:
    v_cmp_ne_u32 vcc, s76, v251
    s_nop 0
    s_cmp_eq_u64 vcc, 0
    s_cselect_b32 s67, 1, 0
    s_mov_b64 exec, -1
    v_mov_b64 v[54:55], 0
    v_mov_b64 v[56:57], 0
    v_mov_b64 v[58:59], 0
    s_mov_b32 s66, 0
    s_mov_b32 s62, 0xffff0000
    s_mov_b32 s65, 31
    v_mov_b32 v71, s56
    s_barrier
L_gp_6:
    s_add_u32 s59, s90, 0
    s_bitcmp1_b32 s65, 0
    s_cselect_b32 s59, s59, 0x7fff0000
    buffer_load_dwordx4 v[24:27], v204, s[48:51], s59 offen sc1
    s_add_u32 s59, s90, 17920
    s_bitcmp1_b32 s65, 1
    s_cselect_b32 s59, s59, 0x7fff0000
    buffer_load_dwordx4 v[28:31], v204, s[48:51], s59 offen sc1
    s_add_u32 s59, s90, 35840
    s_bitcmp1_b32 s65, 2
    s_cselect_b32 s59, s59, 0x7fff0000
    buffer_load_dwordx4 v[32:35], v204, s[48:51], s59 offen sc1
    s_add_u32 s59, s90, 53760
    s_bitcmp1_b32 s65, 3
    s_cselect_b32 s59, s59, 0x7fff0000
    buffer_load_dwordx4 v[36:39], v204, s[48:51], s59 offen sc1
    s_add_u32 s59, s90, 0
    s_bitcmp1_b32 s65, 4
    s_cselect_b32 s59, s59, 0x7fff0000
    s_mov_b32 exec_hi, 0
    buffer_load_dwordx4 v[40:43], v207, s[48:51], s59 offen sc1
    s_mov_b64 exec, -1
    s_waitcnt vmcnt(4)
    v_cmp_ne_u32 vcc, s56, v27
    s_cbranch_vccnz L_gs_10
    s_bitset0_b32 s65, 0
    v_lshlrev_b32 v48, 16, v24
    v_and_b32 v49, s62, v24
    v_lshlrev_b32 v50, 16, v25
    v_and_b32 v51, s62, v25
    v_lshlrev_b32 v52, 16, v26
    v_and_b32 v53, s62, v26
L_gs_10:
    s_waitcnt vmcnt(3)
    v_cmp_ne_u32 vcc, s56, v31
    s_cbranch_vccnz L_gs_11
    s_bitset0_b32 s65, 1
    v_lshlrev_b32 v72, 16, v28
    v_and_b32 v73, s62, v28
    v_lshlrev_b32 v74, 16, v29
    v_and_b32 v75, s62, v29
    v_lshlrev_b32 v76, 16, v30
    v_and_b32 v77, s62, v30
L_gs_11:
    s_waitcnt vmcnt(2)
    v_cmp_ne_u32 vcc, s56, v35
    s_cbranch_vccnz L_gs_12
    s_bitset0_b32 s65, 2
    v_lshlrev_b32 v78, 16, v32
    v_and_b32 v79, s62, v32
    v_lshlrev_b32 v80, 16, v33
    v_and_b32 v81, s62, v33
    v_lshlrev_b32 v82, 16, v34
    v_and_b32 v83, s62, v34
L_gs_12:
    s_waitcnt vmcnt(1)
    v_cmp_ne_u32 vcc, s56, v39
    s_cbranch_vccnz L_gs_13
    s_bitset0_b32 s65, 3
    v_lshlrev_b32 v84, 16, v36
    v_and_b32 v85, s62, v36
    v_lshlrev_b32 v86, 16, v37
    v_and_b32 v87, s62, v37
    v_lshlrev_b32 v88, 16, v38
    v_and_b32 v89, s62, v38
L_gs_13:
    s_mov_b32 exec_hi, 0
    s_waitcnt vmcnt(0)
    v_cmp_ne_u32 vcc, s56, v43
    s_cbranch_vccnz L_gs_14
    s_bitset0_b32 s65, 4
    v_lshlrev_b32 v54, 16, v40
    v_and_b32 v55, s62, v40
    v_lshlrev_b32 v56, 16, v41
    v_and_b32 v57, s62, v41
    v_lshlrev_b32 v58, 16, v42
    v_and_b32 v59, s62, v42
L_gs_14:
    s_mov_b64 exec, -1
    s_cmp_eq_u32 s65, 0
    s_cbranch_scc1 L_gok_7
    s_add_u32 s66, s66, 1
    s_cmp_lt_u32 s66, 200000
    s_cbranch_scc1 L_gp_6
L_gok_7:
    v_pk_add_f32 v[48:49], v[48:49], v[72:73]
    v_pk_add_f32 v[78:79], v[78:79], v[84:85]
    v_pk_add_f32 v[50:51], v[50:51], v[74:75]
    v_pk_add_f32 v[80:81], v[80:81], v[86:87]
    v_pk_add_f32 v[52:53], v[52:53], v[76:77]
    v_pk_add_f32 v[82:83], v[82:83], v[88:89]
    v_pk_add_f32 v[48:49], v[48:49], v[78:79]
    v_pk_add_f32 v[50:51], v[50:51], v[80:81]
    v_pk_add_f32 v[52:53], v[52:53], v[82:83]
    v_add_f32_dpp v54, v54, v54 row_ror:2 row_mask:0xf bank_mask:0xf
    v_add_f32_dpp v55, v55, v55 row_ror:2 row_mask:0xf bank_mask:0xf
    v_add_f32_dpp v56, v56, v56 row_ror:2 row_mask:0xf bank_mask:0xf
    v_add_f32_dpp v57, v57, v57 row_ror:2 row_mask:0xf bank_mask:0xf
    v_add_f32_dpp v58, v58, v58 row_ror:2 row_mask:0xf bank_mask:0xf
    v_add_f32_dpp v59, v59, v59 row_ror:2 row_mask:0xf bank_mask:0xf
    v_add_f32_dpp v54, v54, v54 row_ror:4 row_mask:0xf bank_mask:0xf
    v_add_f32_dpp v55, v55, v55 row_ror:4 row_mask:0xf bank_mask:0xf
    v_add_f32_dpp v56, v56, v56 row_ror:4 row_mask:0xf bank_mask:0xf
    v_add_f32_dpp v57, v57, v57 row_ror:4 row_mask:0xf bank_mask:0xf
    v_add_f32_dpp v58, v58, v58 row_ror:4 row_mask:0xf bank_mask:0xf
    v_add_f32_dpp v59, v59, v59 row_ror:4 row_mask:0xf bank_mask:0xf
    v_add_f32_dpp v54, v54, v54 row_ror:8 row_mask:0xf bank_mask:0xf
    v_add_f32_dpp v55, v55, v55 row_ror:8 row_mask:0xf bank_mask:0xf
    v_add_f32_dpp v56, v56, v56 row_ror:8 row_mask:0xf bank_mask:0xf
    v_add_f32_dpp v57, v57, v57 row_ror:8 row_mask:0xf bank_mask:0xf
    v_add_f32_dpp v58, v58, v58 row_ror:8 row_mask:0xf bank_mask:0xf
    v_add_f32_dpp v59, v59, v59 row_ror:8 row_mask:0xf bank_mask:0xf
    v_mov_b32 v24, v48
    v_mov_b32 v25, v49
    v_mov_b32 v26, v50
    v_mov_b32 v27, v51
    v_mov_b32 v28, v52
    v_mov_b32 v29, v53
    v_permlane32_swap_b32 v48, v24
    v_permlane32_swap_b32 v49, v25
    v_permlane32_swap_b32 v50, v26
    v_permlane32_swap_b32 v51, v27
    v_permlane32_swap_b32 v52, v28
    v_permlane32_swap_b32 v53, v29
    v_add_f32 v48, v48, v24
    v_add_f32 v49, v49, v25
    v_add_f32 v50, v50, v26
    v_add_f32 v51, v51, v27
    v_add_f32 v52, v52, v28
    v_add_f32 v53, v53, v29
    v_mov_b32 v24, v48
    v_mov_b32 v25, v49
    v_mov_b32 v26, v50
    v_mov_b32 v27, v51
    v_mov_b32 v28, v52
    v_mov_b32 v29, v53
    v_mov_b32 v30, v54
    v_mov_b32 v31, v55
    v_mov_b32 v32, v56
    v_mov_b32 v33, v57
    v_mov_b32 v34, v58
    v_mov_b32 v35, v59
    v_permlane16_swap_b32 v48, v24
    v_permlane16_swap_b32 v49, v25
    v_permlane16_swap_b32 v50, v26
    v_permlane16_swap_b32 v51, v27
    v_permlane16_swap_b32 v52, v28
    v_permlane16_swap_b32 v53, v29
    v_permlane16_swap_b32 v54, v30
    v_permlane16_swap_b32 v55, v31
    v_permlane16_swap_b32 v56, v32
    v_permlane16_swap_b32 v57, v33
    v_permlane16_swap_b32 v58, v34
    v_permlane16_swap_b32 v59, v35
    v_add_f32 v48, v48, v24
    v_add_f32 v49, v49, v25
    v_add_f32 v50, v50, v26
    v_add_f32 v51, v51, v27
    v_add_f32 v52, v52, v28
    v_add_f32 v53, v53, v29
    v_add_f32 v54, v54, v30
    v_add_f32 v55, v55, v31
    v_add_f32 v56, v56, v32
    v_add_f32 v57, v57, v33
    v_add_f32 v58, v58, v34
    v_add_f32 v59, v59, v35
    v_cvt_pk_bf16_f32 v68, v54, v55
    v_cvt_pk_bf16_f32 v69, v56, v57
    v_cvt_pk_bf16_f32 v70, v58, v59
    s_mov_b64 exec, 0xffff
    v_cvt_pk_bf16_f32 v68, v48, v49
    v_cvt_pk_bf16_f32 v69, v50, v51
    v_cvt_pk_bf16_f32 v70, v52, v53
    s_mul_i32 s59, s54, 1152
    s_add_u32 s59, s59, s86
    s_mov_b64 exec, 0x3ffff
    s_cmp_eq_u32 s67, 0
    s_cbranch_scc1 L_s2s_15
    buffer_store_dwordx4 v[68:71], v200, s[48:51], s59 offen
    s_branch L_s2g_16
L_s2s_15:
    buffer_store_dwordx4 v[68:71], v200, s[48:51], s59 offen sc1
L_s2g_16:
    ds_write_b32 v201, v68 offset:0
    ds_write_b32 v201, v69 offset:4
    ds_write_b32 v201, v70 offset:8
    s_cmp_eq_u32 s55, 3
    s_cselect_b32 exec_lo, 0x3ffff, -1
    s_cselect_b32 exec_hi, 0, -1
    s_mov_b32 s66, 0
L_g2_17:
    buffer_load_dwordx4 v[24:27], v202, s[48:51], s86 offen sc1
    s_waitcnt vmcnt(0)
    v_cmp_ne_u32 vcc, s56, v27
    s_cbranch_vccz L_g2ok_18
    s_add_u32 s66, s66, 1
    s_cmp_lt_u32 s66, 200000
    s_cbranch_scc1 L_g2_17
L_g2ok_18:
    ds_write_b32 v203, v24 offset:0
    ds_write_b32 v203, v25 offset:4
    ds_write_b32 v203, v26 offset:8
    s_mov_b64 exec, -1
    s_waitcnt lgkmcnt(0)
    s_barrier
    s_mov_b32 s65, 4
L_wo_19:
    s_add_u32 s61, s65, s54
    s_and_b32 s61, s61, 3
    s_add_u32 s61, s61, 1
    s_cmp_eq_u32 s65, 4
    s_cselect_b32 s61, 0, s61
    s_lshl_b32 s61, s61, 2
    s_add_u32 s61, s61, s55
    s_mul_i32 s59, s61, 40960
    s_mul_i32 s60, s61, 5120
    s_add_u32 s60, s60, 30720
    s_add_u32 m0, s60, 0
    s_nop 0
    buffer_load_dwordx4 v13, s[44:47], s59 offen lds
    s_add_u32 m0, s60, 1024
    s_nop 0
    buffer_load_dwordx4 v14, s[44:47], s59 offen lds
    s_add_u32 m0, s60, 2048
    s_nop 0
    buffer_load_dwordx4 v15, s[44:47], s59 offen lds
    s_add_u32 m0, s60, 3072
    s_nop 0
    buffer_load_dwordx4 v16, s[44:47], s59 offen lds
    s_add_u32 m0, s60, 4096
    s_nop 0
    buffer_load_dwordx4 v17, s[44:47], s59 offen lds
    s_add_u32 s65, s65, 1
    s_cmp_lt_u32 s65, 5
    s_cbranch_scc1 L_wo_19
    s_waitcnt vmcnt(0)
    s_barrier
    s_endpgm
L_AC:
    v_and_b32 v250, 15, v0
    v_lshrrev_b32 v251, 4, v0
    v_lshrrev_b32 v252, 1, v250
    v_xor_b32 v252, v252, v251
    s_lshl_b32 s59, s55, 12
    v_lshlrev_b32 v252, 4, v252
    v_lshl_add_u32 v252, v250, 7, v252
    v_add_u32 v1, s59, v252
    v_xor_b32 v2, 64, v1
    v_lshrrev_b32 v252, 2, v0
    v_mul_u32_u24 v252, 480, v252
    v_and_b32 v253, 3, v0
    v_lshl_add_u32 v252, v253, 3, v252
    v_add_u32 v3, 16384, v252
    v_mov_b32 v4, 0x3fb8aa3b
    v_mov_b32 v5, 0xb5c1a2a0
    v_mov_b32 v6, 0x358637bd
    v_mov_b32 v8, v6
    v_mov_b32 v9, v6
    v_mov_b32 v10, v6
    v_mov_b32 v11, v6
    v_mov_b32 v12, v6
    v_mov_b32 v13, v6
    v_mov_b32 v14, v6
    v_mov_b32 v15, v6
    v_mov_b32 v16, v6
    v_mov_b32 v17, v6
    v_mov_b32 v18, v6
    v_mov_b32 v19, v6
    v_mov_b32 v20, v6
    v_mov_b32 v21, v6
    v_mov_b32 v22, v6
    v_mov_b32 v23, v6
    v_mov_b32 v24, v6
    v_mov_b32 v25, v6
    v_mov_b32 v26, v6
    v_mov_b32 v27, v6
    v_mov_b32 v28, v6
    v_mov_b32 v29, v6
    v_mov_b32 v30, v6
    v_mov_b32 v31, v6
    v_mov_b32 v32, v6
    v_mov_b32 v33, v6
    v_mov_b32 v34, v6
    v_mov_b32 v35, v6
    v_mov_b32 v36, v6
    v_mov_b32 v37, v6
    v_mov_b32 v38, v6
    v_mov_b32 v39, v6
    v_mov_b32 v40, v6
    v_mov_b32 v41, v6
    v_mov_b32 v42, v6
    v_mov_b32 v43, v6
    v_mov_b32 v44, v6
    v_mov_b32 v45, v6
    v_mov_b32 v46, v6
    v_mov_b32 v47, v6
    v_mov_b32 v48, v6
    v_mov_b32 v49, v6
    v_mov_b32 v50, v6
    v_mov_b32 v51, v6
    v_mov_b32 v52, v6
    v_mov_b32 v53, v6
    v_mov_b32 v54, v6
    v_mov_b32 v55, v6
    v_mov_b32 v56, v6
    v_mov_b32 v57, v6
    v_mov_b32 v58, v6
    v_mov_b32 v59, v6
    v_mov_b32 v60, v6
    v_mov_b32 v61, v6
    v_mov_b32 v62, v6
    v_mov_b32 v63, v6
    v_mov_b32 v64, v6
    v_mov_b32 v65, v6
    v_mov_b32 v66, v6
    v_mov_b32 v67, v6
    v_mov_b32 v68, v6
    v_mov_b32 v69, v6
    v_mov_b32 v70, v6
    v_mov_b32 v71, v6
    v_mov_b32 v72, v6
    v_mov_b32 v73, v6
    v_mov_b32 v74, v6
    v_mov_b32 v75, v6
    v_mov_b32 v76, v6
    v_mov_b32 v77, v6
    v_mov_b32 v78, v6
    v_mov_b32 v79, v6
    v_mov_b32 v80, v6
    v_mov_b32 v81, v6
    v_mov_b32 v82, v6
    v_mov_b32 v83, v6
    v_mov_b32 v84, v6
    v_mov_b32 v85, v6
    v_mov_b32 v86, v6
    v_mov_b32 v87, v6
    v_mov_b32 v88, 0
    v_mov_b32 v89, 0
    v_mov_b32 v90, 0
    v_mov_b32 v91, 0
    v_mov_b32 v92, 0
    v_mov_b32 v93, 0
    v_mov_b32 v94, 0
    v_mov_b32 v95, 0
    v_mov_b32 v96, 0
    v_mov_b32 v97, 0
    v_mov_b32 v98, 0
    v_mov_b32 v99, 0
    v_mov_b32 v100, 0
    v_mov_b32 v101, 0
    v_mov_b32 v102, 0
    v_mov_b32 v103, 0
    v_mov_b32 v104, 0
    v_mov_b32 v105, 0
    v_mov_b32 v106, 0
    v_mov_b32 v107, 0
    v_mov_b32 v108, 0
    v_mov_b32 v109, 0
    v_mov_b32 v110, 0
    v_mov_b32 v111, 0
    v_mov_b32 v112, 0
    v_mov_b32 v113, 0
    v_mov_b32 v114, 0
    v_mov_b32 v115, 0
    v_mov_b32 v116, 0
    v_mov_b32 v117, 0
    v_mov_b32 v118, 0
    v_mov_b32 v119, 0
    v_mov_b32 v120, 0
    v_mov_b32 v121, 0
    v_mov_b32 v122, 0
    v_mov_b32 v123, 0
    v_mov_b32 v124, 0
    v_mov_b32 v125, 0
    v_mov_b32 v126, 0
    v_mov_b32 v127, 0
    s_mul_i32 s59, s55, 6720
    s_add_u32 s59, s59, 133120
    v_lshlrev_b32 v252, 4, v251
    v_add_u32 v252, s59, v252
    v_mul_u32_u24 v253, 80, v250
    v_add_u32 v205, v252, v253
    v_add_u32 v254, -4, v250
    v_lshlrev_b32 v253, 2, v254
    v_add_u32 v253, v253, v251
    v_mul_u32_u24 v253, 52, v253
    v_lshrrev_b32 v253, 8, v253
    v_mul_u32_u24 v253, 1600, v253
    v_lshl_add_u32 v253, v254, 6, v253
    v_add_u32 v253, 1600, v253
    v_add_u32 v206, v252, v253
    v_lshlrev_b32 v184, 4, v0
    v_add_u32 v184, 160000, v184
    s_mov_b64 exec, -1
    v_add_u32 v184, 0, v205
    s_mov_b64 exec, -1
    v_lshlrev_b32 v185, 4, v0
    v_add_u32 v185, 160000, v185
    s_mov_b32 exec_lo, 0xfff0000f
    s_mov_b32 exec_hi, 0xfff0fff0
    v_add_u32 v185, 1344, v205
    s_mov_b64 exec, -1
    v_lshlrev_b32 v186, 4, v0
    v_add_u32 v186, 160000, v186
    s_mov_b32 exec_lo, 0xff00ff
    s_mov_b32 exec_hi, 0xff00ff00
    v_add_u32 v186, 2688, v205
    s_mov_b64 exec, -1
    v_lshlrev_b32 v187, 4, v0
    v_add_u32 v187, 160000, v187
    s_mov_b32 exec_lo, 0xfff0fff0
    s_mov_b32 exec_hi, 0x0
    v_add_u32 v187, 1408, v205
    s_mov_b64 exec, -1
    s_mov_b32 s94, 0x0
    s_mov_b32 s95, 0xfff0fff
    s_mov_b32 exec_lo, 0x0
    s_mov_b32 exec_hi, 0xfff0fff
    v_add_u32 v187, 3968, v205
    s_mov_b64 exec, -1
    v_lshlrev_b32 v188, 4, v0
    v_add_u32 v188, 160000, v188
    s_mov_b32 exec_lo, 0xfff0fff
    s_mov_b32 exec_hi, 0xf0000fff
    v_add_u32 v188, 4032, v205
    s_mov_b64 exec, -1
    v_lshlrev_b32 v189, 4, v0
    v_add_u32 v189, 160000, v189
    s_mov_b32 exec_lo, 0xffff
    s_mov_b32 exec_hi, 0x0
    v_add_u32 v189, 64, v205
    s_mov_b64 exec, -1
    s_mov_b32 s96, 0x0
    s_mov_b32 s97, 0xffff0000
    s_mov_b32 exec_lo, 0x0
    s_mov_b32 exec_hi, 0xffff0000
    v_add_u32 v189, 5312, v205
    s_mov_b64 exec, -1
    v_lshlrev_b32 v190, 4, v0
    v_add_u32 v190, 160000, v190
    s_mov_b32 exec_lo, 0xff0000
    s_mov_b32 exec_hi, 0xff00ff
    v_add_u32 v190, 2624, v205
    s_mov_b64 exec, -1
    s_mov_b32 s98, 0xff00ff00
    s_mov_b32 s99, 0xff00
    s_mov_b32 exec_lo, 0xff00ff00
    s_mov_b32 exec_hi, 0xff00
    v_add_u32 v190, 2752, v205
    s_mov_b64 exec, -1
    v_lshlrev_b32 v191, 4, v0
    v_add_u32 v191, 160000, v191
    s_mov_b64 exec, -1
    v_add_u32 v191, 5376, v205
    s_mov_b64 exec, -1
    v_lshlrev_b32 v192, 4, v0
    v_add_u32 v192, 160000, v192
    s_mov_b32 exec_lo, 0xf000f
    s_mov_b32 exec_hi, 0xf000f
    v_add_u32 v192, 1280, v205
    s_mov_b64 exec, -1
    s_mov_b32 s100, 0xf000f000
    s_mov_b32 s101, 0xf000f000
    s_mov_b32 exec_lo, 0xf000f000
    s_mov_b32 exec_hi, 0xf000f000
    v_add_u32 v192, 4096, v205
    s_mov_b64 exec, -1
    s_mov_b32 s74, 0x1f001f0
    s_mov_b32 s75, 0x1f001f0
    s_mov_b32 exec_lo, 0x1f001f0
    s_mov_b32 exec_hi, 0x1f001f0
    v_mov_b32 v192, v206
    s_mov_b64 exec, -1
    v_lshlrev_b32 v252, 3, v251
    v_add_u32 v252, 160000, v252
    v_mul_u32_u24 v253, 40, v250
    v_add_u32 v207, v252, v253
    v_and_b32 v253, 3, v250
    v_mul_u32_u24 v253, 800, v253
    v_add_u32 v208, v252, v253
    v_lshrrev_b32 v252, 2, v0
    v_mul_u32_u24 v252, 160, v252
    v_and_b32 v253, 3, v0
    v_lshl_add_u32 v252, v253, 3, v252
    v_add_u32 v209, 30720, v252
    v_lshlrev_b32 v213, 4, v0
    v_mov_b32 v253, 0x3f803f80
    v_cmp_eq_u32 vcc, 4, v250
    s_nop 1
    v_cndmask_b32 v216, 0, v253, vcc
    v_mov_b32 v217, v216
    v_mov_b32 v218, v216
    v_mov_b32 v219, v216
    v_cmp_eq_u32 vcc, 5, v250
    s_nop 1
    v_cndmask_b32 v220, 0, v253, vcc
    v_mov_b32 v221, v220
    v_mov_b32 v222, v220
    v_mov_b32 v223, v220
    v_cmp_eq_u32 vcc, 6, v250
    s_nop 1
    v_cndmask_b32 v224, 0, v253, vcc
    v_mov_b32 v225, v224
    v_mov_b32 v226, v224
    v_mov_b32 v227, v224
    v_cmp_eq_u32 vcc, 7, v250
    s_nop 1
    v_cndmask_b32 v228, 0, v253, vcc
    v_mov_b32 v229, v228
    v_mov_b32 v230, v228
    v_mov_b32 v231, v228
    v_cmp_eq_u32 vcc, 8, v250
    s_nop 1
    v_cndmask_b32 v232, 0, v253, vcc
    v_mov_b32 v233, v232
    v_mov_b32 v234, v232
    v_mov_b32 v235, v232
    s_lshl_b32 s59, s55, 6
    v_add_u32 v210, s59, v0
    v_mul_u32_u24 v211, 24, v210
    v_add_u32 v211, 133120, v211
    v_lshlrev_b32 v210, 4, v210
    s_mul_i32 s59, s55, 6
    s_add_u32 s59, s59, 256
    v_add_u32 v200, s59, v0
    v_mul_u32_u24 v201, 24, v200
    v_add_u32 v201, 133120, v201
    v_lshlrev_b32 v200, 4, v200
    s_mul_i32 s90, s53, 71680
    s_add_u32 s90, s90, 196608
    s_mul_i32 s91, s52, 4480
    s_add_u32 s91, s91, s90
    s_lshl_b32 s92, s52, 2
    s_add_u32 s92, s92, s55
    s_mul_i32 s92, s92, 40960
    s_add_u32 s92, s92, 1048576
    s_waitcnt lgkmcnt(0)
    s_lshl_b32 s59, s35, 8
    s_load_dword s56, s[32:33], s59
    s_mov_b32 s48, s32
    s_mov_b32 s49, s33
    s_mov_b32 s50, 268435456
    s_mov_b32 s51, 0x20000
    s_mov_b32 s44, s28
    s_mov_b32 s45, s29
    s_mov_b32 s46, 10485760
    s_mov_b32 s47, 0x20000
    v_lshrrev_b32 v253, 4, v0
    v_mul_u32_u24 v253, 20480, v253
    v_and_b32 v254, 15, v0
    v_lshl_add_u32 v253, v254, 2, v253
    s_lshl_b32 s59, s52, 2
    s_add_u32 s59, s59, s55
    s_mul_i32 s59, s59, 163840
    s_mul_i32 s60, s53, 320
    s_add_u32 s59, s59, s60
    v_add_u32 v214, s59, v253
    s_cmp_lg_u32 s55, 0
    s_cbranch_scc1 L_ac_nopf
    s_getpc_b64 s[68:69]
L_pc_20:
    s_sub_u32 s68, s68, L_pc_20-L_AL
    s_subb_u32 s69, s69, 0
    s_lshl_b32 s59, s54, 3
    s_add_u32 s59, s59, s53
    s_lshl_b32 s59, s59, 7
    v_lshlrev_b32 v249, 12, v0
    v_add_u32 v249, s59, v249
    v_cmp_gt_u32 vcc, L_BL-L_AL, v249
    s_and_saveexec_b64 s[70:71], vcc
    s_cbranch_execz L_pcs_21
    global_load_dword v255, v249, s[68:69]
L_pcs_21:
    s_mov_b64 exec, -1
L_ac_nopf:
    s_waitcnt lgkmcnt(0)
    s_mul_i32 s56, s56, 1664525
    s_add_u32 s56, s56, 1013904223
    s_max_u32 s56, s56, 16
    s_mov_b32 s58, 0
    s_mov_b32 s65, 0
    s_mov_b32 s60, 47104
    s_barrier
    ds_read_b128 v[128:131], v1 offset:0
    ds_read_b128 v[132:135], v1 offset:2048
    ds_read_b64_tr_b16 v[144:145], v3 offset:160
    ds_read_b64_tr_b16 v[146:147], v3 offset:7840
    ds_read_b64_tr_b16 v[148:149], v3 offset:192
    ds_read_b64_tr_b16 v[150:151], v3 offset:7872
    ds_read_b64_tr_b16 v[152:153], v3 offset:224
    ds_read_b64_tr_b16 v[154:155], v3 offset:7904
    ds_read_b64_tr_b16 v[156:157], v3 offset:256
    ds_read_b64_tr_b16 v[158:159], v3 offset:7936
    ds_read_b64_tr_b16 v[160:161], v3 offset:288
    ds_read_b64_tr_b16 v[162:163], v3 offset:7968
    .p2align 3
L_main_23:
    s_waitcnt lgkmcnt(8)
    v_mfma_f32_16x16x32_bf16 v[48:51], v[128:131], v[144:147], v[48:51]
    ds_read_b64_tr_b16 v[164:165], v3 offset:320
    ds_read_b64_tr_b16 v[166:167], v3 offset:8000
    v_mfma_f32_16x16x32_bf16 v[52:55], v[132:135], v[144:147], v[52:55]
    s_waitcnt lgkmcnt(8)
    ds_read_b64_tr_b16 v[168:169], v3 offset:352
    v_mfma_f32_16x16x32_bf16 v[56:59], v[128:131], v[148:151], v[56:59]
    ds_read_b64_tr_b16 v[170:171], v3 offset:8032
    s_waitcnt lgkmcnt(8)
    v_mfma_f32_16x16x32_bf16 v[60:63], v[132:135], v[148:151], v[60:63]
    ds_read_b64_tr_b16 v[172:173], v3 offset:384
    ds_read_b64_tr_b16 v[174:175], v3 offset:8064
    v_mfma_f32_16x16x32_bf16 v[64:67], v[128:131], v[152:155], v[64:67]
    s_add_u32 s58, s58, 1
    s_cmp_eq_u32 s58, 3
    v_mfma_f32_16x16x32_bf16 v[68:71], v[132:135], v[152:155], v[68:71]
    s_cselect_b32 s59, 0xfffe9000, s60
    s_cselect_b32 s58, 0, s58
    s_waitcnt lgkmcnt(8)
    v_mfma_f32_16x16x32_bf16 v[72:75], v[128:131], v[156:159], v[72:75]
    ds_read_b64_tr_b16 v[176:177], v3 offset:416
    v_mfma_f32_16x16x32_bf16 v[76:79], v[132:135], v[156:159], v[76:79]
    ds_read_b64_tr_b16 v[178:179], v3 offset:8096
    s_waitcnt lgkmcnt(8)
    v_mfma_f32_16x16x32_bf16 v[80:83], v[128:131], v[160:163], v[80:83]
    ds_read_b64_tr_b16 v[180:181], v3 offset:448
    v_mfma_f32_16x16x32_bf16 v[84:87], v[132:135], v[160:163], v[84:87]
    ds_read_b64_tr_b16 v[182:183], v3 offset:8128
    s_waitcnt lgkmcnt(8)
    v_mfma_f32_16x16x32_bf16 v[88:91], v[128:131], v[164:167], v[88:91]
    ds_read_b64_tr_b16 v[144:145], v3 offset:0
    v_mfma_f32_16x16x32_bf16 v[92:95], v[132:135], v[164:167], v[92:95]
    ds_read_b64_tr_b16 v[146:147], v3 offset:7680
    s_waitcnt lgkmcnt(8)
    v_mfma_f32_16x16x32_bf16 v[96:99], v[128:131], v[168:171], v[96:99]
    ds_read_b64_tr_b16 v[148:149], v3 offset:32
    v_mfma_f32_16x16x32_bf16 v[100:103], v[132:135], v[168:171], v[100:103]
    ds_read_b64_tr_b16 v[150:151], v3 offset:7712
    s_waitcnt lgkmcnt(8)
    v_mfma_f32_16x16x32_bf16 v[104:107], v[128:131], v[172:175], v[104:107]
    ds_read_b64_tr_b16 v[152:153], v3 offset:64
    v_mfma_f32_16x16x32_bf16 v[108:111], v[132:135], v[172:175], v[108:111]
    ds_read_b64_tr_b16 v[154:155], v3 offset:7744
    s_waitcnt lgkmcnt(8)
    v_mfma_f32_16x16x32_bf16 v[112:115], v[128:131], v[176:179], v[112:115]
    ds_read_b64_tr_b16 v[156:157], v3 offset:96
    v_mfma_f32_16x16x32_bf16 v[116:119], v[132:135], v[176:179], v[116:119]
    ds_read_b64_tr_b16 v[158:159], v3 offset:7776
    s_waitcnt lgkmcnt(8)
    v_mfma_f32_16x16x32_bf16 v[120:123], v[128:131], v[180:183], v[120:123]
    ds_read_b64_tr_b16 v[160:161], v3 offset:128
    ds_read_b64_tr_b16 v[162:163], v3 offset:7808
    v_mfma_f32_16x16x32_bf16 v[124:127], v[132:135], v[180:183], v[124:127]
    s_waitcnt lgkmcnt(8)
    ds_read_b128 v[136:139], v2 offset:0
    v_mfma_f32_16x16x32_bf16 v[8:11], v[144:147], v[128:131], v[8:11]
    ds_read_b128 v[140:143], v2 offset:2048
    ds_read_b64_tr_b16 v[164:165], v3 offset:15520
    v_mfma_f32_16x16x32_bf16 v[12:15], v[144:147], v[132:135], v[12:15]
    ds_read_b64_tr_b16 v[166:167], v3 offset:23200
    s_waitcnt lgkmcnt(10)
    v_mfma_f32_16x16x32_bf16 v[16:19], v[148:151], v[128:131], v[16:19]
    ds_read_b64_tr_b16 v[168:169], v3 offset:15552
    v_mfma_f32_16x16x32_bf16 v[20:23], v[148:151], v[132:135], v[20:23]
    ds_read_b64_tr_b16 v[170:171], v3 offset:23232
    s_waitcnt lgkmcnt(10)
    v_mfma_f32_16x16x32_bf16 v[24:27], v[152:155], v[128:131], v[24:27]
    ds_read_b64_tr_b16 v[172:173], v3 offset:15584
    v_mfma_f32_16x16x32_bf16 v[28:31], v[152:155], v[132:135], v[28:31]
    ds_read_b64_tr_b16 v[174:175], v3 offset:23264
    s_waitcnt lgkmcnt(10)
    v_mfma_f32_16x16x32_bf16 v[32:35], v[156:159], v[128:131], v[32:35]
    ds_read_b64_tr_b16 v[176:177], v3 offset:15616
    v_mfma_f32_16x16x32_bf16 v[36:39], v[156:159], v[132:135], v[36:39]
    ds_read_b64_tr_b16 v[178:179], v3 offset:23296
    s_waitcnt lgkmcnt(10)
    v_mfma_f32_16x16x32_bf16 v[40:43], v[160:163], v[128:131], v[40:43]
    ds_read_b64_tr_b16 v[180:181], v3 offset:15648
    v_mfma_f32_16x16x32_bf16 v[44:47], v[160:163], v[132:135], v[44:47]
    ds_read_b64_tr_b16 v[182:183], v3 offset:23328
    s_waitcnt lgkmcnt(8)
    v_mfma_f32_16x16x32_bf16 v[48:51], v[136:139], v[164:167], v[48:51]
    ds_read_b64_tr_b16 v[144:145], v3 offset:15680
    v_mfma_f32_16x16x32_bf16 v[52:55], v[140:143], v[164:167], v[52:55]
    ds_read_b64_tr_b16 v[146:147], v3 offset:23360
    s_waitcnt lgkmcnt(8)
    v_mfma_f32_16x16x32_bf16 v[56:59], v[136:139], v[168:171], v[56:59]
    ds_read_b64_tr_b16 v[148:149], v3 offset:15712
    v_mfma_f32_16x16x32_bf16 v[60:63], v[140:143], v[168:171], v[60:63]
    ds_read_b64_tr_b16 v[150:151], v3 offset:23392
    s_waitcnt lgkmcnt(8)
    v_mfma_f32_16x16x32_bf16 v[64:67], v[136:139], v[172:175], v[64:67]
    ds_read_b64_tr_b16 v[152:153], v3 offset:15744
    v_mfma_f32_16x16x32_bf16 v[68:71], v[140:143], v[172:175], v[68:71]
    ds_read_b64_tr_b16 v[154:155], v3 offset:23424
    s_waitcnt lgkmcnt(8)
    v_mfma_f32_16x16x32_bf16 v[72:75], v[136:139], v[176:179], v[72:75]
    ds_read_b64_tr_b16 v[156:157], v3 offset:15776
    v_mfma_f32_16x16x32_bf16 v[76:79], v[140:143], v[176:179], v[76:79]
    ds_read_b64_tr_b16 v[158:159], v3 offset:23456
    s_waitcnt lgkmcnt(8)
    v_mfma_f32_16x16x32_bf16 v[80:83], v[136:139], v[180:183], v[80:83]
    ds_read_b64_tr_b16 v[160:161], v3 offset:15808
    ds_read_b64_tr_b16 v[162:163], v3 offset:23488
    v_mfma_f32_16x16x32_bf16 v[84:87], v[140:143], v[180:183], v[84:87]
    s_waitcnt lgkmcnt(8)
    ds_read_b64_tr_b16 v[164:165], v3 offset:15360
    v_mfma_f32_16x16x32_bf16 v[88:91], v[136:139], v[144:147], v[88:91]
    ds_read_b64_tr_b16 v[166:167], v3 offset:23040
    s_waitcnt lgkmcnt(8)
    v_mfma_f32_16x16x32_bf16 v[92:95], v[140:143], v[144:147], v[92:95]
    ds_read_b64_tr_b16 v[168:169], v3 offset:15392
    ds_read_b64_tr_b16 v[170:171], v3 offset:23072
    v_mfma_f32_16x16x32_bf16 v[96:99], v[136:139], v[148:151], v[96:99]
    ds_read_b64_tr_b16 v[172:173], v3 offset:15424
    ds_read_b64_tr_b16 v[174:175], v3 offset:23104
    v_mfma_f32_16x16x32_bf16 v[100:103], v[140:143], v[148:151], v[100:103]
    s_waitcnt lgkmcnt(10)
    ds_read_b64_tr_b16 v[176:177], v3 offset:15456
    v_mfma_f32_16x16x32_bf16 v[104:107], v[136:139], v[152:155], v[104:107]
    ds_read_b64_tr_b16 v[178:179], v3 offset:23136
    ds_read_b64_tr_b16 v[180:181], v3 offset:15488
    v_mfma_f32_16x16x32_bf16 v[108:111], v[140:143], v[152:155], v[108:111]
    ds_read_b64_tr_b16 v[182:183], v3 offset:23168
    s_waitcnt lgkmcnt(12)
    v_mfma_f32_16x16x32_bf16 v[112:115], v[136:139], v[156:159], v[112:115]
    v_mfma_f32_16x16x32_bf16 v[116:119], v[140:143], v[156:159], v[116:119]
    s_waitcnt lgkmcnt(10)
    v_add_u32 v1, s59, v1
    v_mfma_f32_16x16x32_bf16 v[120:123], v[136:139], v[160:163], v[120:123]
    v_add_u32 v2, s59, v2
    v_add_u32 v3, s59, v3
    v_mfma_f32_16x16x32_bf16 v[124:127], v[140:143], v[160:163], v[124:127]
    s_cmp_eq_u32 s65, 9
    s_waitcnt lgkmcnt(0)
    v_mfma_f32_16x16x32_bf16 v[8:11], v[164:167], v[136:139], v[8:11]
    s_cbranch_scc1 L_nb_22
    s_barrier
L_nb_22:
    v_mfma_f32_16x16x32_bf16 v[12:15], v[164:167], v[140:143], v[12:15]
    ds_read_b128 v[128:131], v1 offset:0
    ds_read_b128 v[132:135], v1 offset:2048
    v_mfma_f32_16x16x32_bf16 v[16:19], v[168:171], v[136:139], v[16:19]
    ds_read_b64_tr_b16 v[144:145], v3 offset:160
    ds_read_b64_tr_b16 v[146:147], v3 offset:7840
    v_mfma_f32_16x16x32_bf16 v[20:23], v[168:171], v[140:143], v[20:23]
    ds_read_b64_tr_b16 v[148:149], v3 offset:192
    ds_read_b64_tr_b16 v[150:151], v3 offset:7872
    v_mfma_f32_16x16x32_bf16 v[24:27], v[172:175], v[136:139], v[24:27]
    v_mfma_f32_16x16x32_bf16 v[28:31], v[172:175], v[140:143], v[28:31]
    ds_read_b64_tr_b16 v[152:153], v3 offset:224
    ds_read_b64_tr_b16 v[154:155], v3 offset:7904
    v_mfma_f32_16x16x32_bf16 v[32:35], v[176:179], v[136:139], v[32:35]
    s_add_u32 s65, s65, 1
    s_cmp_lt_u32 s65, 10
    v_mfma_f32_16x16x32_bf16 v[36:39], v[176:179], v[140:143], v[36:39]
    ds_read_b64_tr_b16 v[156:157], v3 offset:256
    ds_read_b64_tr_b16 v[158:159], v3 offset:7936
    v_mfma_f32_16x16x32_bf16 v[40:43], v[180:183], v[136:139], v[40:43]
    ds_read_b64_tr_b16 v[160:161], v3 offset:288
    ds_read_b64_tr_b16 v[162:163], v3 offset:7968
    v_mfma_f32_16x16x32_bf16 v[44:47], v[180:183], v[140:143], v[44:47]
    s_cbranch_scc1 L_main_23
    s_waitcnt lgkmcnt(0)
    v_pk_fma_f32 v[240:241], v[48:49], v[4:5], v[4:5] op_sel:[0,0,1] op_sel_hi:[1,0,1]
    v_pk_fma_f32 v[242:243], v[50:51], v[4:5], v[4:5] op_sel:[0,0,1] op_sel_hi:[1,0,1]
    v_pk_fma_f32 v[244:245], v[52:53], v[4:5], v[4:5] op_sel:[0,0,1] op_sel_hi:[1,0,1]
    v_pk_fma_f32 v[246:247], v[54:55], v[4:5], v[4:5] op_sel:[0,0,1] op_sel_hi:[1,0,1]
    v_exp_f32_e64 v240, v240 clamp
    v_max_f32 v48, v48, v6
    v_exp_f32_e64 v241, v241 clamp
    v_max_f32 v49, v49, v6
    v_exp_f32_e64 v242, v242 clamp
    v_max_f32 v50, v50, v6
    v_exp_f32_e64 v243, v243 clamp
    v_max_f32 v51, v51, v6
    v_exp_f32_e64 v244, v244 clamp
    v_max_f32 v52, v52, v6
    v_exp_f32_e64 v245, v245 clamp
    v_max_f32 v53, v53, v6
    v_exp_f32_e64 v246, v246 clamp
    v_max_f32 v54, v54, v6
    v_exp_f32_e64 v247, v247 clamp
    v_max_f32 v55, v55, v6
    v_pk_add_f32 v[48:49], v[48:49], v[240:241]
    v_pk_add_f32 v[50:51], v[50:51], v[242:243]
    v_pk_add_f32 v[52:53], v[52:53], v[244:245]
    v_pk_add_f32 v[54:55], v[54:55], v[246:247]
    v_cvt_pk_bf16_f32 v48, v48, v49
    v_cvt_pk_bf16_f32 v49, v50, v51
    v_cvt_pk_bf16_f32 v50, v52, v53
    v_cvt_pk_bf16_f32 v51, v54, v55
    v_cvt_pk_bf16_f32 v88, v88, v89
    v_cvt_pk_bf16_f32 v89, v90, v91
    v_cvt_pk_bf16_f32 v90, v92, v93
    v_cvt_pk_bf16_f32 v91, v94, v95
    v_cvt_pk_bf16_f32 v96, v96, v97
    v_cvt_pk_bf16_f32 v97, v98, v99
    v_cvt_pk_bf16_f32 v98, v100, v101
    v_cvt_pk_bf16_f32 v99, v102, v103
    v_mfma_f32_16x16x32_bf16 v[52:55], v[48:51], v[88:91], 0
    s_nop 0
    v_mfma_f32_16x16x32_bf16 v[92:95], v[48:51], v[96:99], 0
    v_mfma_f32_16x16x32_bf16 v[196:199], v[48:51], v[216:219], 0
    v_pk_fma_f32 v[240:241], v[56:57], v[4:5], v[4:5] op_sel:[0,0,1] op_sel_hi:[1,0,1]
    v_pk_fma_f32 v[242:243], v[58:59], v[4:5], v[4:5] op_sel:[0,0,1] op_sel_hi:[1,0,1]
    v_pk_fma_f32 v[244:245], v[60:61], v[4:5], v[4:5] op_sel:[0,0,1] op_sel_hi:[1,0,1]
    v_pk_fma_f32 v[246:247], v[62:63], v[4:5], v[4:5] op_sel:[0,0,1] op_sel_hi:[1,0,1]
    v_exp_f32_e64 v240, v240 clamp
    v_max_f32 v56, v56, v6
    v_exp_f32_e64 v241, v241 clamp
    v_max_f32 v57, v57, v6
    v_exp_f32_e64 v242, v242 clamp
    v_max_f32 v58, v58, v6
    v_exp_f32_e64 v243, v243 clamp
    v_max_f32 v59, v59, v6
    v_exp_f32_e64 v244, v244 clamp
    v_max_f32 v60, v60, v6
    v_exp_f32_e64 v245, v245 clamp
    v_max_f32 v61, v61, v6
    v_exp_f32_e64 v246, v246 clamp
    v_max_f32 v62, v62, v6
    v_exp_f32_e64 v247, v247 clamp
    v_max_f32 v63, v63, v6
    v_pk_add_f32 v[56:57], v[56:57], v[240:241]
    v_pk_add_f32 v[58:59], v[58:59], v[242:243]
    v_pk_add_f32 v[60:61], v[60:61], v[244:245]
    v_pk_add_f32 v[62:63], v[62:63], v[246:247]
    v_cvt_pk_bf16_f32 v56, v56, v57
    v_cvt_pk_bf16_f32 v57, v58, v59
    v_cvt_pk_bf16_f32 v58, v60, v61
    v_cvt_pk_bf16_f32 v59, v62, v63
    v_cvt_pk_bf16_f32 v104, v104, v105
    v_cvt_pk_bf16_f32 v105, v106, v107
    v_cvt_pk_bf16_f32 v106, v108, v109
    v_cvt_pk_bf16_f32 v107, v110, v111
    ds_write_b128 v184, v[52:55]
    v_mfma_f32_16x16x32_bf16 v[60:63], v[56:59], v[96:99], 0
    v_mfma_f32_16x16x32_bf16 v[100:103], v[56:59], v[88:91], 0
    v_mfma_f32_16x16x32_bf16 v[108:111], v[56:59], v[104:107], 0
    v_mfma_f32_16x16x32_bf16 v[196:199], v[56:59], v[220:223], v[196:199]
    v_pk_fma_f32 v[240:241], v[64:65], v[4:5], v[4:5] op_sel:[0,0,1] op_sel_hi:[1,0,1]
    v_pk_fma_f32 v[242:243], v[66:67], v[4:5], v[4:5] op_sel:[0,0,1] op_sel_hi:[1,0,1]
    v_pk_fma_f32 v[244:245], v[68:69], v[4:5], v[4:5] op_sel:[0,0,1] op_sel_hi:[1,0,1]
    v_pk_fma_f32 v[246:247], v[70:71], v[4:5], v[4:5] op_sel:[0,0,1] op_sel_hi:[1,0,1]
    v_exp_f32_e64 v240, v240 clamp
    v_max_f32 v64, v64, v6
    v_exp_f32_e64 v241, v241 clamp
    v_max_f32 v65, v65, v6
    v_exp_f32_e64 v242, v242 clamp
    v_max_f32 v66, v66, v6
    v_exp_f32_e64 v243, v243 clamp
    v_max_f32 v67, v67, v6
    v_exp_f32_e64 v244, v244 clamp
    v_max_f32 v68, v68, v6
    v_exp_f32_e64 v245, v245 clamp
    v_max_f32 v69, v69, v6
    v_exp_f32_e64 v246, v246 clamp
    v_max_f32 v70, v70, v6
    v_exp_f32_e64 v247, v247 clamp
    v_max_f32 v71, v71, v6
    v_pk_add_f32 v[64:65], v[64:65], v[240:241]
    v_pk_add_f32 v[66:67], v[66:67], v[242:243]
    v_pk_add_f32 v[68:69], v[68:69], v[244:245]
    v_pk_add_f32 v[70:71], v[70:71], v[246:247]
    v_cvt_pk_bf16_f32 v64, v64, v65
    v_cvt_pk_bf16_f32 v65, v66, v67
    v_cvt_pk_bf16_f32 v66, v68, v69
    v_cvt_pk_bf16_f32 v67, v70, v71
    v_cvt_pk_bf16_f32 v112, v112, v113
    v_cvt_pk_bf16_f32 v113, v114, v115
    v_cvt_pk_bf16_f32 v114, v116, v117
    v_cvt_pk_bf16_f32 v115, v118, v119
    ds_write_b128 v185, v[60:63]
    v_mfma_f32_16x16x32_bf16 v[68:71], v[64:67], v[104:107], 0
    v_mfma_f32_16x16x32_bf16 v[116:119], v[64:67], v[96:99], 0
    v_mfma_f32_16x16x32_bf16 v[236:239], v[64:67], v[112:115], 0
    v_mfma_f32_16x16x32_bf16 v[196:199], v[64:67], v[224:227], v[196:199]
    v_pk_fma_f32 v[240:241], v[72:73], v[4:5], v[4:5] op_sel:[0,0,1] op_sel_hi:[1,0,1]
    v_pk_fma_f32 v[242:243], v[74:75], v[4:5], v[4:5] op_sel:[0,0,1] op_sel_hi:[1,0,1]
    v_pk_fma_f32 v[244:245], v[76:77], v[4:5], v[4:5] op_sel:[0,0,1] op_sel_hi:[1,0,1]
    v_pk_fma_f32 v[246:247], v[78:79], v[4:5], v[4:5] op_sel:[0,0,1] op_sel_hi:[1,0,1]
    v_exp_f32_e64 v240, v240 clamp
    v_max_f32 v72, v72, v6
    v_exp_f32_e64 v241, v241 clamp
    v_max_f32 v73, v73, v6
    v_exp_f32_e64 v242, v242 clamp
    v_max_f32 v74, v74, v6
    v_exp_f32_e64 v243, v243 clamp
    v_max_f32 v75, v75, v6
    v_exp_f32_e64 v244, v244 clamp
    v_max_f32 v76, v76, v6
    v_exp_f32_e64 v245, v245 clamp
    v_max_f32 v77, v77, v6
    v_exp_f32_e64 v246, v246 clamp
    v_max_f32 v78, v78, v6
    v_exp_f32_e64 v247, v247 clamp
    v_max_f32 v79, v79, v6
    v_pk_add_f32 v[72:73], v[72:73], v[240:241]
    v_pk_add_f32 v[74:75], v[74:75], v[242:243]
    v_pk_add_f32 v[76:77], v[76:77], v[244:245]
    v_pk_add_f32 v[78:79], v[78:79], v[246:247]
    v_cvt_pk_bf16_f32 v72, v72, v73
    v_cvt_pk_bf16_f32 v73, v74, v75
    v_cvt_pk_bf16_f32 v74, v76, v77
    v_cvt_pk_bf16_f32 v75, v78, v79
    v_cvt_pk_bf16_f32 v120, v120, v121
    v_cvt_pk_bf16_f32 v121, v122, v123
    v_cvt_pk_bf16_f32 v122, v124, v125
    v_cvt_pk_bf16_f32 v123, v126, v127
    ds_write_b128 v186, v[68:71]
    v_cndmask_b32 v116, v116, v236, s[94:95]
    v_cndmask_b32 v117, v117, v237, s[94:95]
    v_cndmask_b32 v118, v118, v238, s[94:95]
    v_cndmask_b32 v119, v119, v239, s[94:95]
    ds_write_b128 v187, v[116:119]
    v_mfma_f32_16x16x32_bf16 v[76:79], v[72:75], v[112:115], 0
    v_mfma_f32_16x16x32_bf16 v[124:127], v[72:75], v[104:107], 0
    v_mfma_f32_16x16x32_bf16 v[216:219], v[72:75], v[120:123], 0
    v_mfma_f32_16x16x32_bf16 v[196:199], v[72:75], v[228:231], v[196:199]
    v_pk_fma_f32 v[240:241], v[80:81], v[4:5], v[4:5] op_sel:[0,0,1] op_sel_hi:[1,0,1]
    v_pk_fma_f32 v[242:243], v[82:83], v[4:5], v[4:5] op_sel:[0,0,1] op_sel_hi:[1,0,1]
    v_pk_fma_f32 v[244:245], v[84:85], v[4:5], v[4:5] op_sel:[0,0,1] op_sel_hi:[1,0,1]
    v_pk_fma_f32 v[246:247], v[86:87], v[4:5], v[4:5] op_sel:[0,0,1] op_sel_hi:[1,0,1]
    v_exp_f32_e64 v240, v240 clamp
    v_max_f32 v80, v80, v6
    v_exp_f32_e64 v241, v241 clamp
    v_max_f32 v81, v81, v6
    v_exp_f32_e64 v242, v242 clamp
    v_max_f32 v82, v82, v6
    v_exp_f32_e64 v243, v243 clamp
    v_max_f32 v83, v83, v6
    v_exp_f32_e64 v244, v244 clamp
    v_max_f32 v84, v84, v6
    v_exp_f32_e64 v245, v245 clamp
    v_max_f32 v85, v85, v6
    v_exp_f32_e64 v246, v246 clamp
    v_max_f32 v86, v86, v6
    v_exp_f32_e64 v247, v247 clamp
    v_max_f32 v87, v87, v6
    v_pk_add_f32 v[80:81], v[80:81], v[240:241]
    v_pk_add_f32 v[82:83], v[82:83], v[242:243]
    v_pk_add_f32 v[84:85], v[84:85], v[244:245]
    v_pk_add_f32 v[86:87], v[86:87], v[246:247]
    v_cvt_pk_bf16_f32 v80, v80, v81
    v_cvt_pk_bf16_f32 v81, v82, v83
    v_cvt_pk_bf16_f32 v82, v84, v85
    v_cvt_pk_bf16_f32 v83, v86, v87
    ds_write_b128 v188, v[76:79]
    v_cndmask_b32 v100, v100, v216, s[96:97]
    v_cndmask_b32 v101, v101, v217, s[96:97]
    v_cndmask_b32 v102, v102, v218, s[96:97]
    v_cndmask_b32 v103, v103, v219, s[96:97]
    ds_write_b128 v189, v[100:103]
    v_cndmask_b32 v108, v108, v124, s[98:99]
    v_cndmask_b32 v109, v109, v125, s[98:99]
    v_cndmask_b32 v110, v110, v126, s[98:99]
    v_cndmask_b32 v111, v111, v127, s[98:99]
    ds_write_b128 v190, v[108:111]
    v_mfma_f32_16x16x32_bf16 v[84:87], v[80:83], v[120:123], 0
    v_mfma_f32_16x16x32_bf16 v[220:223], v[80:83], v[112:115], 0
    v_mfma_f32_16x16x32_bf16 v[196:199], v[80:83], v[232:235], v[196:199]
    s_nop 5
    ds_write_b128 v191, v[84:87]
    v_cndmask_b32 v92, v92, v220, s[100:101]
    v_cndmask_b32 v93, v93, v221, s[100:101]
    v_cndmask_b32 v94, v94, v222, s[100:101]
    v_cndmask_b32 v95, v95, v223, s[100:101]
    v_cndmask_b32 v92, v92, v196, s[74:75]
    v_cndmask_b32 v93, v93, v197, s[74:75]
    v_cndmask_b32 v94, v94, v198, s[74:75]
    v_cndmask_b32 v95, v95, v199, s[74:75]
    ds_write_b128 v192, v[92:95]
    s_waitcnt lgkmcnt(0)
    s_barrier
    ds_read_b64 v[128:129], v211 offset:0
    ds_read_b64 v[130:131], v211 offset:8
    ds_read_b64 v[132:133], v211 offset:16
    ds_read_b64 v[134:135], v211 offset:6720
    ds_read_b64 v[136:137], v211 offset:6728
    ds_read_b64 v[138:139], v211 offset:6736
    ds_read_b64 v[140:141], v211 offset:13440
    ds_read_b64 v[142:143], v211 offset:13448
    ds_read_b64 v[144:145], v211 offset:13456
    ds_read_b64 v[146:147], v211 offset:20160
    ds_read_b64 v[148:149], v211 offset:20168
    ds_read_b64 v[150:151], v211 offset:20176
    v_mov_b32 v155, s56
    ds_read_b64 v[156:157], v201 offset:0
    ds_read_b64 v[158:159], v201 offset:8
    ds_read_b64 v[160:161], v201 offset:16
    ds_read_b64 v[162:163], v201 offset:6720
    ds_read_b64 v[164:165], v201 offset:6728
    ds_read_b64 v[166:167], v201 offset:6736
    ds_read_b64 v[168:169], v201 offset:13440
    ds_read_b64 v[170:171], v201 offset:13448
    ds_read_b64 v[172:173], v201 offset:13456
    ds_read_b64 v[174:175], v201 offset:20160
    ds_read_b64 v[176:177], v201 offset:20168
    ds_read_b64 v[178:179], v201 offset:20176
    v_mov_b32 v183, s56
    s_waitcnt lgkmcnt(12)
    v_pk_add_f32 v[128:129], v[128:129], v[134:135]
    v_pk_add_f32 v[140:141], v[140:141], v[146:147]
    v_pk_add_f32 v[130:131], v[130:131], v[136:137]
    v_pk_add_f32 v[142:143], v[142:143], v[148:149]
    v_pk_add_f32 v[132:133], v[132:133], v[138:139]
    v_pk_add_f32 v[144:145], v[144:145], v[150:151]
    v_pk_add_f32 v[128:129], v[128:129], v[140:141]
    v_pk_add_f32 v[130:131], v[130:131], v[142:143]
    v_pk_add_f32 v[132:133], v[132:133], v[144:145]
    v_cvt_pk_bf16_f32 v152, v128, v129
    v_cvt_pk_bf16_f32 v153, v130, v131
    v_cvt_pk_bf16_f32 v154, v132, v133
    buffer_store_dwordx4 v[152:155], v210, s[48:51], s91 offen sc1
    s_waitcnt lgkmcnt(0)
    v_pk_add_f32 v[156:157], v[156:157], v[162:163]
    v_pk_add_f32 v[168:169], v[168:169], v[174:175]
    v_pk_add_f32 v[158:159], v[158:159], v[164:165]
    v_pk_add_f32 v[170:171], v[170:171], v[176:177]
    v_pk_add_f32 v[160:161], v[160:161], v[166:167]
    v_pk_add_f32 v[172:173], v[172:173], v[178:179]
    v_pk_add_f32 v[156:157], v[156:157], v[168:169]
    v_pk_add_f32 v[158:159], v[158:159], v[170:171]
    v_pk_add_f32 v[160:161], v[160:161], v[172:173]
    v_cvt_pk_bf16_f32 v180, v156, v157
    v_cvt_pk_bf16_f32 v181, v158, v159
    v_cvt_pk_bf16_f32 v182, v160, v161
    s_mov_b64 exec, 0x3f
    buffer_store_dwordx4 v[180:183], v200, s[48:51], s91 offen sc1
    s_mov_b64 exec, -1
    s_lshl_b32 s67, s35, 4
    s_add_u32 s67, s67, s52
    s_lshl_b32 s67, s67, 10
    s_add_u32 s67, s67, 4096
    s_lshl_b32 s64, s55, 7
    s_add_u32 s64, s64, s67
    s_add_u32 s67, s67, 512
    s_mov_b64 exec, 0xff
    v_lshlrev_b32 v250, 2, v0
    buffer_load_dword v252, v250, s[48:51], s64 offen sc1
    buffer_load_dword v251, v250, s[48:51], s67 offen sc1
    s_mov_b64 exec, -1
    v_pk_fma_f32 v[240:241], v[8:9], v[4:5], v[4:5] op_sel:[0,0,1] op_sel_hi:[1,0,1]
    v_pk_fma_f32 v[242:243], v[10:11], v[4:5], v[4:5] op_sel:[0,0,1] op_sel_hi:[1,0,1]
    v_pk_fma_f32 v[244:245], v[12:13], v[4:5], v[4:5] op_sel:[0,0,1] op_sel_hi:[1,0,1]
    v_pk_fma_f32 v[246:247], v[14:15], v[4:5], v[4:5] op_sel:[0,0,1] op_sel_hi:[1,0,1]
    v_exp_f32_e64 v240, v240 clamp
    v_max_f32 v8, v8, v6
    v_exp_f32_e64 v241, v241 clamp
    v_max_f32 v9, v9, v6
    v_exp_f32_e64 v242, v242 clamp
    v_max_f32 v10, v10, v6
    v_exp_f32_e64 v243, v243 clamp
    v_max_f32 v11, v11, v6
    v_exp_f32_e64 v244, v244 clamp
    v_max_f32 v12, v12, v6
    v_exp_f32_e64 v245, v245 clamp
    v_max_f32 v13, v13, v6
    v_exp_f32_e64 v246, v246 clamp
    v_max_f32 v14, v14, v6
    v_exp_f32_e64 v247, v247 clamp
    v_max_f32 v15, v15, v6
    v_pk_add_f32 v[8:9], v[8:9], v[240:241]
    v_pk_add_f32 v[10:11], v[10:11], v[242:243]
    v_pk_add_f32 v[12:13], v[12:13], v[244:245]
    v_pk_add_f32 v[14:15], v[14:15], v[246:247]
    v_cvt_pk_bf16_f32 v48, v8, v9
    v_cvt_pk_bf16_f32 v49, v10, v11
    v_cvt_pk_bf16_f32 v60, v12, v13
    v_cvt_pk_bf16_f32 v61, v14, v15
    v_pk_fma_f32 v[240:241], v[16:17], v[4:5], v[4:5] op_sel:[0,0,1] op_sel_hi:[1,0,1]
    v_pk_fma_f32 v[242:243], v[18:19], v[4:5], v[4:5] op_sel:[0,0,1] op_sel_hi:[1,0,1]
    v_pk_fma_f32 v[244:245], v[20:21], v[4:5], v[4:5] op_sel:[0,0,1] op_sel_hi:[1,0,1]
    v_pk_fma_f32 v[246:247], v[22:23], v[4:5], v[4:5] op_sel:[0,0,1] op_sel_hi:[1,0,1]
    v_exp_f32_e64 v240, v240 clamp
    v_max_f32 v16, v16, v6
    v_exp_f32_e64 v241, v241 clamp
    v_max_f32 v17, v17, v6
    v_exp_f32_e64 v242, v242 clamp
    v_max_f32 v18, v18, v6
    v_exp_f32_e64 v243, v243 clamp
    v_max_f32 v19, v19, v6
    v_exp_f32_e64 v244, v244 clamp
    v_max_f32 v20, v20, v6
    v_exp_f32_e64 v245, v245 clamp
    v_max_f32 v21, v21, v6
    v_exp_f32_e64 v246, v246 clamp
    v_max_f32 v22, v22, v6
    v_exp_f32_e64 v247, v247 clamp
    v_max_f32 v23, v23, v6
    v_pk_add_f32 v[16:17], v[16:17], v[240:241]
    v_pk_add_f32 v[18:19], v[18:19], v[242:243]
    v_pk_add_f32 v[20:21], v[20:21], v[244:245]
    v_pk_add_f32 v[22:23], v[22:23], v[246:247]
    v_cvt_pk_bf16_f32 v50, v16, v17
    v_cvt_pk_bf16_f32 v51, v18, v19
    v_cvt_pk_bf16_f32 v62, v20, v21
    v_cvt_pk_bf16_f32 v63, v22, v23
    v_pk_fma_f32 v[240:241], v[24:25], v[4:5], v[4:5] op_sel:[0,0,1] op_sel_hi:[1,0,1]
    v_pk_fma_f32 v[242:243], v[26:27], v[4:5], v[4:5] op_sel:[0,0,1] op_sel_hi:[1,0,1]
    v_pk_fma_f32 v[244:245], v[28:29], v[4:5], v[4:5] op_sel:[0,0,1] op_sel_hi:[1,0,1]
    v_pk_fma_f32 v[246:247], v[30:31], v[4:5], v[4:5] op_sel:[0,0,1] op_sel_hi:[1,0,1]
    v_exp_f32_e64 v240, v240 clamp
    v_max_f32 v24, v24, v6
    v_exp_f32_e64 v241, v241 clamp
    v_max_f32 v25, v25, v6
    v_exp_f32_e64 v242, v242 clamp
    v_max_f32 v26, v26, v6
    v_exp_f32_e64 v243, v243 clamp
    v_max_f32 v27, v27, v6
    v_exp_f32_e64 v244, v244 clamp
    v_max_f32 v28, v28, v6
    v_exp_f32_e64 v245, v245 clamp
    v_max_f32 v29, v29, v6
    v_exp_f32_e64 v246, v246 clamp
    v_max_f32 v30, v30, v6
    v_exp_f32_e64 v247, v247 clamp
    v_max_f32 v31, v31, v6
    v_pk_add_f32 v[24:25], v[24:25], v[240:241]
    v_pk_add_f32 v[26:27], v[26:27], v[242:243]
    v_pk_add_f32 v[28:29], v[28:29], v[244:245]
    v_pk_add_f32 v[30:31], v[30:31], v[246:247]
    v_cvt_pk_bf16_f32 v52, v24, v25
    v_cvt_pk_bf16_f32 v53, v26, v27
    v_cvt_pk_bf16_f32 v64, v28, v29
    v_cvt_pk_bf16_f32 v65, v30, v31
    v_pk_fma_f32 v[240:241], v[32:33], v[4:5], v[4:5] op_sel:[0,0,1] op_sel_hi:[1,0,1]
    v_pk_fma_f32 v[242:243], v[34:35], v[4:5], v[4:5] op_sel:[0,0,1] op_sel_hi:[1,0,1]
    v_pk_fma_f32 v[244:245], v[36:37], v[4:5], v[4:5] op_sel:[0,0,1] op_sel_hi:[1,0,1]
    v_pk_fma_f32 v[246:247], v[38:39], v[4:5], v[4:5] op_sel:[0,0,1] op_sel_hi:[1,0,1]
    v_exp_f32_e64 v240, v240 clamp
    v_max_f32 v32, v32, v6
    v_exp_f32_e64 v241, v241 clamp
    v_max_f32 v33, v33, v6
    v_exp_f32_e64 v242, v242 clamp
    v_max_f32 v34, v34, v6
    v_exp_f32_e64 v243, v243 clamp
    v_max_f32 v35, v35, v6
    v_exp_f32_e64 v244, v244 clamp
    v_max_f32 v36, v36, v6
    v_exp_f32_e64 v245, v245 clamp
    v_max_f32 v37, v37, v6
    v_exp_f32_e64 v246, v246 clamp
    v_max_f32 v38, v38, v6
    v_exp_f32_e64 v247, v247 clamp
    v_max_f32 v39, v39, v6
    v_pk_add_f32 v[32:33], v[32:33], v[240:241]
    v_pk_add_f32 v[34:35], v[34:35], v[242:243]
    v_pk_add_f32 v[36:37], v[36:37], v[244:245]
    v_pk_add_f32 v[38:39], v[38:39], v[246:247]
    v_cvt_pk_bf16_f32 v54, v32, v33
    v_cvt_pk_bf16_f32 v55, v34, v35
    v_cvt_pk_bf16_f32 v66, v36, v37
    v_cvt_pk_bf16_f32 v67, v38, v39
    v_pk_fma_f32 v[240:241], v[40:41], v[4:5], v[4:5] op_sel:[0,0,1] op_sel_hi:[1,0,1]
    v_pk_fma_f32 v[242:243], v[42:43], v[4:5], v[4:5] op_sel:[0,0,1] op_sel_hi:[1,0,1]
    v_pk_fma_f32 v[244:245], v[44:45], v[4:5], v[4:5] op_sel:[0,0,1] op_sel_hi:[1,0,1]
    v_pk_fma_f32 v[246:247], v[46:47], v[4:5], v[4:5] op_sel:[0,0,1] op_sel_hi:[1,0,1]
    v_exp_f32_e64 v240, v240 clamp
    v_max_f32 v40, v40, v6
    v_exp_f32_e64 v241, v241 clamp
    v_max_f32 v41, v41, v6
    v_exp_f32_e64 v242, v242 clamp
    v_max_f32 v42, v42, v6
    v_exp_f32_e64 v243, v243 clamp
    v_max_f32 v43, v43, v6
    v_exp_f32_e64 v244, v244 clamp
    v_max_f32 v44, v44, v6
    v_exp_f32_e64 v245, v245 clamp
    v_max_f32 v45, v45, v6
    v_exp_f32_e64 v246, v246 clamp
    v_max_f32 v46, v46, v6
    v_exp_f32_e64 v247, v247 clamp
    v_max_f32 v47, v47, v6
    v_pk_add_f32 v[40:41], v[40:41], v[240:241]
    v_pk_add_f32 v[42:43], v[42:43], v[242:243]
    v_pk_add_f32 v[44:45], v[44:45], v[244:245]
    v_pk_add_f32 v[46:47], v[46:47], v[246:247]
    v_cvt_pk_bf16_f32 v56, v40, v41
    v_cvt_pk_bf16_f32 v57, v42, v43
    v_cvt_pk_bf16_f32 v68, v44, v45
    v_cvt_pk_bf16_f32 v69, v46, v47
    v_mov_b32 v58, 0
    v_mov_b32 v59, 0
    v_mov_b32 v70, 0
    v_mov_b32 v71, 0
    v_mov_b64 v[82:83], 0
    v_mov_b64 v[94:95], 0
    v_mov_b64 v[96:97], 0
    v_mov_b64 v[110:111], 0
    v_mov_b64 v[112:113], 0
    v_mov_b64 v[118:119], 0
    v_mov_b32 v184, 163360
    v_mov_b64 v[246:247], 0
    ds_write_b64 v184, v[246:247]
    s_mov_b32 exec_lo, 0x11111111
    s_mov_b32 exec_hi, 0x11111111
    v_add_u32 v184, 800, v208
    s_mov_b64 exec, -1
    v_mov_b32 v185, 163360
    s_mov_b32 exec_lo, 0x22221111
    s_mov_b32 exec_hi, 0x22222222
    v_add_u32 v185, 832, v208
    s_mov_b64 exec, -1
    v_mov_b32 v186, 163360
    s_mov_b32 exec_lo, 0x22222222
    s_mov_b32 exec_hi, 0x44444444
    v_add_u32 v186, 864, v208
    s_mov_b64 exec, -1
    v_mov_b32 v187, 163360
    s_mov_b32 exec_lo, 0x44444444
    s_mov_b32 exec_hi, 0x88884444
    v_add_u32 v187, 896, v208
    s_mov_b64 exec, -1
    v_mov_b32 v188, 163360
    s_mov_b32 exec_lo, 0x88888888
    s_mov_b32 exec_hi, 0x88888888
    v_add_u32 v188, 928, v208
    s_mov_b64 exec, -1
    v_mov_b32 v189, 163360
    s_mov_b64 exec, -1
    v_add_u32 v189, 0, v207
    s_mov_b64 exec, -1
    v_mov_b32 v190, 163360
    s_mov_b32 exec_lo, 0xffff
    s_mov_b32 exec_hi, 0x0
    v_add_u32 v190, 32, v207
    s_mov_b64 exec, -1
    v_mov_b32 v191, 163360
    s_mov_b32 exec_lo, 0xf000f
    s_mov_b32 exec_hi, 0xf000f
    v_add_u32 v191, 640, v207
    s_mov_b64 exec, -1
    v_mov_b32 v192, 163360
    s_mov_b32 exec_lo, 0xfff0000f
    s_mov_b32 exec_hi, 0xfff0fff0
    v_add_u32 v192, 672, v207
    s_mov_b64 exec, -1
    v_mov_b32 v193, 163360
    s_mov_b32 exec_lo, 0xfff0fff0
    s_mov_b32 exec_hi, 0x0
    v_add_u32 v193, 704, v207
    s_mov_b64 exec, -1
    v_mov_b32 v194, 163360
    s_mov_b32 exec_lo, 0xff0000
    s_mov_b32 exec_hi, 0xff00ff
    v_add_u32 v194, 1312, v207
    s_mov_b64 exec, -1
    v_mov_b32 v195, 163360
    s_mov_b32 exec_lo, 0xff00ff
    s_mov_b32 exec_hi, 0xff00ff00
    v_add_u32 v195, 1344, v207
    s_mov_b64 exec, -1
    v_mov_b32 v196, 163360
    s_mov_b32 exec_lo, 0xff00ff00
    s_mov_b32 exec_hi, 0xff00
    v_add_u32 v196, 1376, v207
    s_mov_b64 exec, -1
    v_mov_b32 v197, 163360
    s_mov_b32 exec_lo, 0x0
    s_mov_b32 exec_hi, 0xfff0fff
    v_add_u32 v197, 1984, v207
    s_mov_b64 exec, -1
    v_mov_b32 v198, 163360
    s_mov_b32 exec_lo, 0xfff0fff
    s_mov_b32 exec_hi, 0xf0000fff
    v_add_u32 v198, 2016, v207
    s_mov_b64 exec, -1
    v_mov_b32 v199, 163360
    s_mov_b32 exec_lo, 0xf000f000
    s_mov_b32 exec_hi, 0xf000f000
    v_add_u32 v199, 2048, v207
    s_mov_b64 exec, -1
    v_mov_b32 v200, 163360
    s_mov_b32 exec_lo, 0x0
    s_mov_b32 exec_hi, 0xffff0000
    v_add_u32 v200, 2656, v207
    s_mov_b64 exec, -1
    v_mov_b32 v201, 163360
    s_mov_b64 exec, -1
    v_add_u32 v201, 2688, v207
    s_mov_b64 exec, -1
    v_mov_b32 v8, v6
    v_mov_b32 v9, v6
    v_mov_b32 v10, v6
    v_mov_b32 v11, v6
    v_mov_b32 v12, v6
    v_mov_b32 v13, v6
    v_mov_b32 v14, v6
    v_mov_b32 v15, v6
    s_mov_b64 s[68:69], 0xffff
    s_mov_b32 s70, -1
    s_mov_b32 s71, 0
    s_mov_b32 s72, -1
    s_mov_b32 s73, 0xffff
    s_mul_i32 s61, s53, 5120
    s_add_u32 s61, s61, s92
    s_barrier
    s_waitcnt lgkmcnt(0)
    s_barrier
    ds_read_b64 v[72:73], v184
    ds_read_b64 v[74:75], v185
    ds_read_b64 v[76:77], v186
    ds_read_b64 v[78:79], v187
    ds_read_b64 v[80:81], v188
    ds_read_b64 v[84:85], v189
    ds_read_b64 v[86:87], v190
    ds_read_b64 v[88:89], v191
    ds_read_b64 v[90:91], v192
    ds_read_b64 v[92:93], v193
    ds_read_b64 v[98:99], v194
    ds_read_b64 v[100:101], v195
    ds_read_b64 v[102:103], v196
    ds_read_b64 v[104:105], v197
    ds_read_b64 v[106:107], v198
    ds_read_b64 v[108:109], v199
    ds_read_b64 v[114:115], v200
    ds_read_b64 v[116:117], v201
    s_waitcnt lgkmcnt(13)
    v_mfma_f32_16x16x32_bf16 v[8:11], v[72:75], v[48:51], v[8:11]
    v_mfma_f32_16x16x32_bf16 v[12:15], v[72:75], v[60:63], v[12:15]
    v_mfma_f32_16x16x32_bf16 v[8:11], v[76:79], v[52:55], v[8:11]
    v_mfma_f32_16x16x32_bf16 v[12:15], v[76:79], v[64:67], v[12:15]
    v_mfma_f32_16x16x32_bf16 v[8:11], v[80:83], v[56:59], v[8:11]
    v_mfma_f32_16x16x32_bf16 v[12:15], v[80:83], v[68:71], v[12:15]
    s_waitcnt lgkmcnt(0)
    v_mfma_f32_16x16x32_bf16 v[128:131], v[84:87], v[48:51], 0
    v_mfma_f32_16x16x32_bf16 v[132:135], v[84:87], v[60:63], 0
    v_mfma_f32_16x16x32_bf16 v[136:139], v[88:91], v[48:51], 0
    v_mfma_f32_16x16x32_bf16 v[140:143], v[88:91], v[60:63], 0
    v_mfma_f32_16x16x32_bf16 v[136:139], v[92:95], v[52:55], v[136:139]
    v_mfma_f32_16x16x32_bf16 v[140:143], v[92:95], v[64:67], v[140:143]
    v_rcp_f32 v8, v8
    v_mfma_f32_16x16x32_bf16 v[144:147], v[96:99], v[48:51], 0
    v_rcp_f32 v9, v9
    v_mfma_f32_16x16x32_bf16 v[148:151], v[96:99], v[60:63], 0
    v_rcp_f32 v10, v10
    v_mfma_f32_16x16x32_bf16 v[144:147], v[100:103], v[52:55], v[144:147]
    v_rcp_f32 v11, v11
    v_mfma_f32_16x16x32_bf16 v[148:151], v[100:103], v[64:67], v[148:151]
    v_rcp_f32 v12, v12
    v_mfma_f32_16x16x32_bf16 v[152:155], v[104:107], v[52:55], 0
    v_rcp_f32 v13, v13
    v_mfma_f32_16x16x32_bf16 v[156:159], v[104:107], v[64:67], 0
    v_rcp_f32 v14, v14
    v_mfma_f32_16x16x32_bf16 v[152:155], v[108:111], v[56:59], v[152:155]
    v_rcp_f32 v15, v15
    v_mfma_f32_16x16x32_bf16 v[156:159], v[108:111], v[68:71], v[156:159]
    v_mov_b32 v16, v8
    v_mov_b32 v20, v11
    v_mfma_f32_16x16x32_bf16 v[160:163], v[112:115], v[52:55], 0
    v_cndmask_b32 v17, v9, v8, s[68:69]
    v_cndmask_b32 v18, v10, v9, s[70:71]
    v_mfma_f32_16x16x32_bf16 v[164:167], v[112:115], v[64:67], 0
    v_cndmask_b32 v19, v11, v10, s[72:73]
    v_mov_b32 v22, v12
    v_mfma_f32_16x16x32_bf16 v[160:163], v[116:119], v[56:59], v[160:163]
    v_mov_b32 v26, v15
    v_cndmask_b32 v23, v13, v12, s[68:69]
    v_mfma_f32_16x16x32_bf16 v[164:167], v[116:119], v[68:71], v[164:167]
    v_cndmask_b32 v24, v14, v13, s[70:71]
    v_cndmask_b32 v25, v15, v14, s[72:73]
    v_pk_mul_f32 v[128:129], v[128:129], v[16:17] op_sel:[0,0] op_sel_hi:[1,0]
    v_pk_mul_f32 v[130:131], v[130:131], v[16:17] op_sel:[0,0] op_sel_hi:[1,0]
    v_pk_mul_f32 v[132:133], v[132:133], v[22:23] op_sel:[0,0] op_sel_hi:[1,0]
    v_pk_mul_f32 v[134:135], v[134:135], v[22:23] op_sel:[0,0] op_sel_hi:[1,0]
    v_cvt_pk_bf16_f32 v28, v128, v129
    v_cvt_pk_bf16_f32 v29, v130, v131
    v_cvt_pk_bf16_f32 v32, v132, v133
    v_cvt_pk_bf16_f32 v33, v134, v135
    v_pk_mul_f32 v[136:137], v[136:137], v[16:17] op_sel:[0,1] op_sel_hi:[1,1]
    v_pk_mul_f32 v[138:139], v[138:139], v[16:17] op_sel:[0,1] op_sel_hi:[1,1]
    v_pk_mul_f32 v[140:141], v[140:141], v[22:23] op_sel:[0,1] op_sel_hi:[1,1]
    v_pk_mul_f32 v[142:143], v[142:143], v[22:23] op_sel:[0,1] op_sel_hi:[1,1]
    v_cvt_pk_bf16_f32 v30, v136, v137
    v_cvt_pk_bf16_f32 v31, v138, v139
    v_cvt_pk_bf16_f32 v34, v140, v141
    v_cvt_pk_bf16_f32 v35, v142, v143
    buffer_store_dwordx4 v[28:31], v213, s[48:51], s61 offen offset:0 sc1
    buffer_store_dwordx4 v[32:35], v213, s[48:51], s61 offen offset:1024 sc1
    v_pk_mul_f32 v[144:145], v[144:145], v[18:19] op_sel:[0,0] op_sel_hi:[1,0]
    v_pk_mul_f32 v[146:147], v[146:147], v[18:19] op_sel:[0,0] op_sel_hi:[1,0]
    v_pk_mul_f32 v[148:149], v[148:149], v[24:25] op_sel:[0,0] op_sel_hi:[1,0]
    v_pk_mul_f32 v[150:151], v[150:151], v[24:25] op_sel:[0,0] op_sel_hi:[1,0]
    v_cvt_pk_bf16_f32 v36, v144, v145
    v_cvt_pk_bf16_f32 v37, v146, v147
    v_cvt_pk_bf16_f32 v40, v148, v149
    v_cvt_pk_bf16_f32 v41, v150, v151
    v_pk_mul_f32 v[152:153], v[152:153], v[18:19] op_sel:[0,1] op_sel_hi:[1,1]
    v_pk_mul_f32 v[154:155], v[154:155], v[18:19] op_sel:[0,1] op_sel_hi:[1,1]
    v_pk_mul_f32 v[156:157], v[156:157], v[24:25] op_sel:[0,1] op_sel_hi:[1,1]
    v_pk_mul_f32 v[158:159], v[158:159], v[24:25] op_sel:[0,1] op_sel_hi:[1,1]
    v_cvt_pk_bf16_f32 v38, v152, v153
    v_cvt_pk_bf16_f32 v39, v154, v155
    v_cvt_pk_bf16_f32 v42, v156, v157
    v_cvt_pk_bf16_f32 v43, v158, v159
    buffer_store_dwordx4 v[36:39], v213, s[48:51], s61 offen offset:2048 sc1
    buffer_store_dwordx4 v[40:43], v213, s[48:51], s61 offen offset:3072 sc1
    v_pk_mul_f32 v[160:161], v[160:161], v[20:21] op_sel:[0,0] op_sel_hi:[1,0]
    v_pk_mul_f32 v[162:163], v[162:163], v[20:21] op_sel:[0,0] op_sel_hi:[1,0]
    v_pk_mul_f32 v[164:165], v[164:165], v[26:27] op_sel:[0,0] op_sel_hi:[1,0]
    v_pk_mul_f32 v[166:167], v[166:167], v[26:27] op_sel:[0,0] op_sel_hi:[1,0]
    v_cvt_pk_bf16_f32 v44, v160, v161
    v_cvt_pk_bf16_f32 v45, v162, v163
    v_cvt_pk_bf16_f32 v46, v164, v165
    v_cvt_pk_bf16_f32 v47, v166, v167
    s_add_u32 s61, s61, 4096
    buffer_store_dwordx4 v[44:47], v213, s[48:51], s61 offen sc1
L_AP2:
    s_xor_b32 s59, s53, 0
    s_mul_i32 s4, s59, 5120
    s_add_u32 s4, s4, s92
    s_mul_i32 s59, s59, 12800
    v_add_u32 v8, s59, v209
    s_xor_b32 s59, s53, 1
    s_mul_i32 s5, s59, 5120
    s_add_u32 s5, s5, s92
    s_mul_i32 s59, s59, 12800
    v_add_u32 v9, s59, v209
    s_and_b32 s59, s53, 6
    s_xor_b32 s59, s59, 2
    s_mul_i32 s6, s59, 5120
    s_add_u32 s6, s6, s92
    s_mul_i32 s59, s59, 12800
    v_add_u32 v10, s59, v209
    s_and_b32 s59, s53, 6
    s_xor_b32 s59, s59, 3
    s_mul_i32 s7, s59, 5120
    s_add_u32 s7, s7, s92
    s_mul_i32 s59, s59, 12800
    v_add_u32 v11, s59, v209
    s_and_b32 s59, s53, 6
    s_xor_b32 s59, s59, 4
    s_mul_i32 s8, s59, 5120
    s_add_u32 s8, s8, s92
    s_mul_i32 s59, s59, 12800
    v_add_u32 v12, s59, v209
    s_and_b32 s59, s53, 6
    s_xor_b32 s59, s59, 5
    s_mul_i32 s9, s59, 5120
    s_add_u32 s9, s9, s92
    s_mul_i32 s59, s59, 12800
    v_add_u32 v13, s59, v209
    s_and_b32 s59, s53, 6
    s_xor_b32 s59, s59, 6
    s_mul_i32 s10, s59, 5120
    s_add_u32 s10, s10, s92
    s_mul_i32 s59, s59, 12800
    v_add_u32 v14, s59, v209
    s_and_b32 s59, s53, 6
    s_xor_b32 s59, s59, 7
    s_mul_i32 s11, s59, 5120
    s_add_u32 s11, s11, s92
    s_mul_i32 s59, s59, 12800
    v_add_u32 v15, s59, v209
    v_add_u32 v1, 4096, v213
    s_mov_b32 s94, 0
    s_mov_b32 s95, 5120
    s_mov_b32 s96, 10240
    s_mov_b32 s97, 15360
    s_mov_b32 s98, 81920
    s_mov_b32 s99, 87040
    s_mov_b32 s100, 92160
    s_mov_b32 s101, 97280
    s_mov_b64 exec, 0xff
    s_mov_b32 s66, 0
    s_branch L_xc_25
L_xp_24:
    buffer_load_dword v251, v250, s[48:51], s67 offen sc1
L_xc_25:
    s_waitcnt vmcnt(0)
    v_xor_b32 v251, s56, v251
    v_cmp_le_u32 vcc, 16, v251
    s_cbranch_vccz L_xok_26
    s_add_u32 s66, s66, 1
    s_cmp_lt_u32 s66, 200000
    s_cbranch_scc1 L_xp_24
L_xok_26:
    v_cmp_ne_u32 vcc, s76, v251
    s_nop 0
    s_cmp_eq_u64 vcc, 0
    s_cselect_b32 s67, 1, 0
    s_mov_b64 exec, -1
    s_lshl_b32 s63, s35, 4
    s_add_u32 s63, s63, s52
    s_lshl_b32 s63, s63, 10
    s_add_u32 s63, s63, 4096
    s_lshl_b32 s64, s55, 7
    s_add_u32 s63, s63, s64
    s_lshl_b32 s64, s53, 2
    s_add_u32 s64, s64, s63
    v_mov_b32 v250, s56
    v_mov_b32 v251, 0
    v_lshlrev_b32 v252, 2, v0
    s_mov_b32 s66, 0
    s_waitcnt vmcnt(0)
    s_mov_b64 exec, 1
    s_cmp_eq_u32 s67, 0
    s_cbranch_scc1 L_slow_27
    buffer_store_dword v250, v251, s[48:51], s64 offen
    s_branch L_go_28
L_slow_27:
    buffer_store_dword v250, v251, s[48:51], s64 offen sc1
L_go_28:
    s_mov_b64 exec, 0xff
    s_mov_b64 exec, -1
    s_barrier
    ds_read_b64_tr_b16 v[132:133], v8 offset:0
    ds_read_b64_tr_b16 v[134:135], v8 offset:2560
    ds_read_b64_tr_b16 v[136:137], v8 offset:32
    ds_read_b64_tr_b16 v[138:139], v8 offset:2592
    ds_read_b64_tr_b16 v[140:141], v8 offset:64
    ds_read_b64_tr_b16 v[142:143], v8 offset:2624
    ds_read_b64_tr_b16 v[144:145], v8 offset:96
    ds_read_b64_tr_b16 v[146:147], v8 offset:2656
    ds_read_b64_tr_b16 v[148:149], v8 offset:128
    ds_read_b64_tr_b16 v[150:151], v8 offset:2688
    ds_read_b64_tr_b16 v[152:153], v8 offset:5120
    ds_read_b64_tr_b16 v[154:155], v8 offset:7680
    ds_read_b64_tr_b16 v[156:157], v8 offset:5152
    ds_read_b64_tr_b16 v[158:159], v8 offset:7712
    s_mov_b64 exec, 0xff
L_fp_29:
    buffer_load_dword v251, v252, s[48:51], s63 offen sc1
    s_waitcnt vmcnt(0)
    v_cmp_ne_u32 vcc, s56, v251
    s_cbranch_vccz L_fok_30
    s_add_u32 s66, s66, 1
    s_cmp_lt_u32 s66, 200000
    s_cbranch_scc1 L_fp_29
L_fok_30:
    s_mov_b64 exec, -1
    buffer_load_dwordx4 v[116:119], v213, s[48:51], s6 offen offset:0 sc1
    buffer_load_dwordx4 v[120:123], v213, s[48:51], s6 offen offset:1024 sc1
    buffer_load_dwordx4 v[124:127], v213, s[48:51], s6 offen offset:2048 sc1
    buffer_load_dwordx4 v[128:131], v213, s[48:51], s6 offen offset:3072 sc1
    buffer_load_dwordx4 v[172:175], v213, s[48:51], s7 offen offset:0 sc1
    buffer_load_dwordx4 v[176:179], v213, s[48:51], s7 offen offset:1024 sc1
    s_waitcnt lgkmcnt(10)
    v_mfma_f32_16x16x32_bf16 v[52:55], v[28:31], v[132:135], 0
    v_mfma_f32_16x16x32_bf16 v[56:59], v[32:35], v[132:135], 0
    ds_read_b64_tr_b16 v[160:161], v8 offset:5184
    ds_read_b64_tr_b16 v[162:163], v8 offset:7744
    v_mfma_f32_16x16x32_bf16 v[60:63], v[28:31], v[136:139], 0
    ds_read_b64_tr_b16 v[164:165], v8 offset:5216
    ds_read_b64_tr_b16 v[166:167], v8 offset:7776
    v_mfma_f32_16x16x32_bf16 v[64:67], v[32:35], v[136:139], 0
    buffer_load_dwordx4 v[180:183], v213, s[48:51], s7 offen offset:2048 sc1
    s_waitcnt lgkmcnt(10)
    v_mfma_f32_16x16x32_bf16 v[68:71], v[28:31], v[140:143], 0
    v_mfma_f32_16x16x32_bf16 v[72:75], v[32:35], v[140:143], 0
    ds_read_b64_tr_b16 v[168:169], v8 offset:5248
    ds_read_b64_tr_b16 v[170:171], v8 offset:7808
    v_mfma_f32_16x16x32_bf16 v[76:79], v[28:31], v[144:147], 0
    ds_read_b64_tr_b16 v[132:133], v10 offset:0
    ds_read_b64_tr_b16 v[134:135], v10 offset:2560
    v_mfma_f32_16x16x32_bf16 v[80:83], v[32:35], v[144:147], 0
    buffer_load_dwordx4 v[184:187], v213, s[48:51], s7 offen offset:3072 sc1
    s_waitcnt lgkmcnt(10)
    v_mfma_f32_16x16x32_bf16 v[84:87], v[28:31], v[148:151], 0
    v_mfma_f32_16x16x32_bf16 v[88:91], v[32:35], v[148:151], 0
    ds_read_b64_tr_b16 v[136:137], v10 offset:32
    ds_read_b64_tr_b16 v[138:139], v10 offset:2592
    v_mfma_f32_16x16x32_bf16 v[52:55], v[36:39], v[152:155], v[52:55]
    ds_read_b64_tr_b16 v[140:141], v10 offset:64
    ds_read_b64_tr_b16 v[142:143], v10 offset:2624
    v_mfma_f32_16x16x32_bf16 v[56:59], v[40:43], v[152:155], v[56:59]
    buffer_load_dwordx4 v[92:95], v1, s[48:51], s6 offen offset:0 sc1
    s_waitcnt lgkmcnt(10)
    v_mfma_f32_16x16x32_bf16 v[60:63], v[36:39], v[156:159], v[60:63]
    v_mfma_f32_16x16x32_bf16 v[64:67], v[40:43], v[156:159], v[64:67]
    ds_read_b64_tr_b16 v[144:145], v10 offset:96
    ds_read_b64_tr_b16 v[146:147], v10 offset:2656
    v_mfma_f32_16x16x32_bf16 v[68:71], v[36:39], v[160:163], v[68:71]
    ds_read_b64_tr_b16 v[148:149], v10 offset:128
    ds_read_b64_tr_b16 v[150:151], v10 offset:2688
    v_mfma_f32_16x16x32_bf16 v[72:75], v[40:43], v[160:163], v[72:75]
    buffer_load_dwordx4 v[96:99], v1, s[48:51], s7 offen offset:0 sc1
    s_waitcnt lgkmcnt(10)
    v_mfma_f32_16x16x32_bf16 v[76:79], v[36:39], v[164:167], v[76:79]
    ds_read_b64_tr_b16 v[152:153], v10 offset:5120
    ds_read_b64_tr_b16 v[154:155], v10 offset:7680
    v_mfma_f32_16x16x32_bf16 v[80:83], v[40:43], v[164:167], v[80:83]
    ds_read_b64_tr_b16 v[156:157], v10 offset:5152
    ds_read_b64_tr_b16 v[158:159], v10 offset:7712
    v_mfma_f32_16x16x32_bf16 v[84:87], v[36:39], v[168:171], v[84:87]
    buffer_load_dwordx4 v[188:191], v213, s[48:51], s8 offen offset:0 sc1
    s_waitcnt vmcnt(10)
    v_mfma_f32_16x16x32_bf16 v[88:91], v[40:43], v[168:171], v[88:91]
    s_waitcnt vmcnt(9)
    s_waitcnt lgkmcnt(10)
    v_mfma_f32_16x16x32_bf16 v[52:55], v[116:119], v[132:135], v[52:55]
    v_mfma_f32_16x16x32_bf16 v[56:59], v[120:123], v[132:135], v[56:59]
    ds_read_b64_tr_b16 v[160:161], v10 offset:5184
    ds_read_b64_tr_b16 v[162:163], v10 offset:7744
    v_mfma_f32_16x16x32_bf16 v[60:63], v[116:119], v[136:139], v[60:63]
    ds_read_b64_tr_b16 v[164:165], v10 offset:5216
    ds_read_b64_tr_b16 v[166:167], v10 offset:7776
    v_mfma_f32_16x16x32_bf16 v[64:67], v[120:123], v[136:139], v[64:67]
    buffer_load_dwordx4 v[192:195], v213, s[48:51], s8 offen offset:1024 sc1
    s_waitcnt lgkmcnt(10)
    v_mfma_f32_16x16x32_bf16 v[68:71], v[116:119], v[140:143], v[68:71]
    v_mfma_f32_16x16x32_bf16 v[72:75], v[120:123], v[140:143], v[72:75]
    ds_read_b64_tr_b16 v[168:169], v10 offset:5248
    ds_read_b64_tr_b16 v[170:171], v10 offset:7808
    v_mfma_f32_16x16x32_bf16 v[76:79], v[116:119], v[144:147], v[76:79]
    ds_read_b64_tr_b16 v[132:133], v11 offset:0
    ds_read_b64_tr_b16 v[134:135], v11 offset:2560
    v_mfma_f32_16x16x32_bf16 v[80:83], v[120:123], v[144:147], v[80:83]
    buffer_load_dwordx4 v[196:199], v213, s[48:51], s8 offen offset:2048 sc1
    s_waitcnt lgkmcnt(10)
    v_mfma_f32_16x16x32_bf16 v[84:87], v[116:119], v[148:151], v[84:87]
    ds_read_b64_tr_b16 v[136:137], v11 offset:32
    ds_read_b64_tr_b16 v[138:139], v11 offset:2592
    v_mfma_f32_16x16x32_bf16 v[88:91], v[120:123], v[148:151], v[88:91]
    s_waitcnt vmcnt(10)
    s_waitcnt vmcnt(9)
    v_mfma_f32_16x16x32_bf16 v[52:55], v[124:127], v[152:155], v[52:55]
    ds_read_b64_tr_b16 v[140:141], v11 offset:64
    ds_read_b64_tr_b16 v[142:143], v11 offset:2624
    v_mfma_f32_16x16x32_bf16 v[56:59], v[128:131], v[152:155], v[56:59]
    buffer_load_dwordx4 v[200:203], v213, s[48:51], s8 offen offset:3072 sc1
    s_waitcnt lgkmcnt(10)
    v_mfma_f32_16x16x32_bf16 v[60:63], v[124:127], v[156:159], v[60:63]
    v_mfma_f32_16x16x32_bf16 v[64:67], v[128:131], v[156:159], v[64:67]
    ds_read_b64_tr_b16 v[144:145], v11 offset:96
    ds_read_b64_tr_b16 v[146:147], v11 offset:2656
    v_mfma_f32_16x16x32_bf16 v[68:71], v[124:127], v[160:163], v[68:71]
    ds_read_b64_tr_b16 v[148:149], v11 offset:128
    ds_read_b64_tr_b16 v[150:151], v11 offset:2688
    v_mfma_f32_16x16x32_bf16 v[72:75], v[128:131], v[160:163], v[72:75]
    buffer_load_dwordx4 v[216:219], v213, s[48:51], s9 offen offset:0 sc1
    s_waitcnt lgkmcnt(10)
    v_mfma_f32_16x16x32_bf16 v[76:79], v[124:127], v[164:167], v[76:79]
    ds_read_b64_tr_b16 v[152:153], v11 offset:5120
    ds_read_b64_tr_b16 v[154:155], v11 offset:7680
    v_mfma_f32_16x16x32_bf16 v[80:83], v[128:131], v[164:167], v[80:83]
    ds_read_b64_tr_b16 v[156:157], v11 offset:5152
    ds_read_b64_tr_b16 v[158:159], v11 offset:7712
    v_mfma_f32_16x16x32_bf16 v[84:87], v[124:127], v[168:171], v[84:87]
    buffer_load_dwordx4 v[220:223], v213, s[48:51], s9 offen offset:1024 sc1
    s_waitcnt vmcnt(11)
    v_mfma_f32_16x16x32_bf16 v[88:91], v[128:131], v[168:171], v[88:91]
    s_waitcnt vmcnt(10)
    s_waitcnt lgkmcnt(10)
    v_mfma_f32_16x16x32_bf16 v[52:55], v[172:175], v[132:135], v[52:55]
    v_mfma_f32_16x16x32_bf16 v[56:59], v[176:179], v[132:135], v[56:59]
    ds_read_b64_tr_b16 v[160:161], v11 offset:5184
    ds_read_b64_tr_b16 v[162:163], v11 offset:7744
    v_mfma_f32_16x16x32_bf16 v[60:63], v[172:175], v[136:139], v[60:63]
    ds_read_b64_tr_b16 v[164:165], v11 offset:5216
    ds_read_b64_tr_b16 v[166:167], v11 offset:7776
    v_mfma_f32_16x16x32_bf16 v[64:67], v[176:179], v[136:139], v[64:67]
    buffer_load_dwordx4 v[224:227], v213, s[48:51], s9 offen offset:2048 sc1
    s_waitcnt lgkmcnt(10)
    v_mfma_f32_16x16x32_bf16 v[68:71], v[172:175], v[140:143], v[68:71]
    ds_read_b64_tr_b16 v[168:169], v11 offset:5248
    v_mfma_f32_16x16x32_bf16 v[72:75], v[176:179], v[140:143], v[72:75]
    ds_read_b64_tr_b16 v[170:171], v11 offset:7808
    ds_read_b64_tr_b16 v[132:133], v10 offset:10240
    v_mfma_f32_16x16x32_bf16 v[76:79], v[172:175], v[144:147], v[76:79]
    ds_read_b64_tr_b16 v[134:135], v11 offset:10240
    buffer_load_dwordx4 v[228:231], v213, s[48:51], s9 offen offset:3072 sc1
    v_mfma_f32_16x16x32_bf16 v[80:83], v[176:179], v[144:147], v[80:83]
    s_waitcnt lgkmcnt(10)
    ds_read_b64_tr_b16 v[136:137], v10 offset:10272
    v_mfma_f32_16x16x32_bf16 v[84:87], v[172:175], v[148:151], v[84:87]
    ds_read_b64_tr_b16 v[138:139], v11 offset:10272
    s_waitcnt vmcnt(11)
    v_mfma_f32_16x16x32_bf16 v[88:91], v[176:179], v[148:151], v[88:91]
    s_waitcnt vmcnt(10)
    ds_read_b64_tr_b16 v[140:141], v10 offset:10304
    v_mfma_f32_16x16x32_bf16 v[52:55], v[180:183], v[152:155], v[52:55]
    ds_read_b64_tr_b16 v[142:143], v11 offset:10304
    buffer_load_dwordx4 v[100:103], v1, s[48:51], s8 offen offset:0 sc1
    v_mfma_f32_16x16x32_bf16 v[56:59], v[184:187], v[152:155], v[56:59]
    s_waitcnt lgkmcnt(10)
    ds_read_b64_tr_b16 v[144:145], v10 offset:10336
    v_mfma_f32_16x16x32_bf16 v[60:63], v[180:183], v[156:159], v[60:63]
    ds_read_b64_tr_b16 v[146:147], v11 offset:10336
    ds_read_b64_tr_b16 v[148:149], v10 offset:10368
    v_mfma_f32_16x16x32_bf16 v[64:67], v[184:187], v[156:159], v[64:67]
    ds_read_b64_tr_b16 v[150:151], v11 offset:10368
    buffer_load_dwordx4 v[104:107], v1, s[48:51], s9 offen offset:0 sc1
    v_mfma_f32_16x16x32_bf16 v[68:71], v[180:183], v[160:163], v[68:71]
    s_waitcnt vmcnt(10)
    v_swap_b32 v94, v96
    v_mfma_f32_16x16x32_bf16 v[72:75], v[184:187], v[160:163], v[72:75]
    v_swap_b32 v95, v97
    s_waitcnt lgkmcnt(10)
    v_mfma_f32_16x16x32_bf16 v[76:79], v[180:183], v[164:167], v[76:79]
    v_mfma_f32_16x16x32_bf16 v[80:83], v[184:187], v[164:167], v[80:83]
    ds_read_b64_tr_b16 v[152:153], v12 offset:0
    ds_read_b64_tr_b16 v[154:155], v12 offset:2560
    v_mfma_f32_16x16x32_bf16 v[84:87], v[180:183], v[168:171], v[84:87]
    ds_read_b64_tr_b16 v[156:157], v12 offset:32
    ds_read_b64_tr_b16 v[158:159], v12 offset:2592
    v_mfma_f32_16x16x32_bf16 v[88:91], v[184:187], v[168:171], v[88:91]
    buffer_load_dwordx4 v[232:235], v213, s[48:51], s10 offen offset:0 sc1
    s_waitcnt lgkmcnt(10)
    v_mfma_f32_16x16x32_bf16 v[52:55], v[92:95], v[132:135], v[52:55]
    v_mfma_f32_16x16x32_bf16 v[56:59], v[96:99], v[132:135], v[56:59]
    ds_read_b64_tr_b16 v[160:161], v12 offset:64
    ds_read_b64_tr_b16 v[162:163], v12 offset:2624
    v_mfma_f32_16x16x32_bf16 v[60:63], v[92:95], v[136:139], v[60:63]
    ds_read_b64_tr_b16 v[164:165], v12 offset:96
    ds_read_b64_tr_b16 v[166:167], v12 offset:2656
    v_mfma_f32_16x16x32_bf16 v[64:67], v[96:99], v[136:139], v[64:67]
    buffer_load_dwordx4 v[236:239], v213, s[48:51], s10 offen offset:1024 sc1
    s_waitcnt lgkmcnt(10)
    v_mfma_f32_16x16x32_bf16 v[68:71], v[92:95], v[140:143], v[68:71]
    v_mfma_f32_16x16x32_bf16 v[72:75], v[96:99], v[140:143], v[72:75]
    ds_read_b64_tr_b16 v[168:169], v12 offset:128
    ds_read_b64_tr_b16 v[170:171], v12 offset:2688
    v_mfma_f32_16x16x32_bf16 v[76:79], v[92:95], v[144:147], v[76:79]
    ds_read_b64_tr_b16 v[132:133], v12 offset:5120
    ds_read_b64_tr_b16 v[134:135], v12 offset:7680
    v_mfma_f32_16x16x32_bf16 v[80:83], v[96:99], v[144:147], v[80:83]
    buffer_load_dwordx4 v[240:243], v213, s[48:51], s10 offen offset:2048 sc1
    s_waitcnt lgkmcnt(10)
    v_mfma_f32_16x16x32_bf16 v[84:87], v[92:95], v[148:151], v[84:87]
    ds_read_b64_tr_b16 v[136:137], v12 offset:5152
    ds_read_b64_tr_b16 v[138:139], v12 offset:7712
    v_mfma_f32_16x16x32_bf16 v[88:91], v[96:99], v[148:151], v[88:91]
    s_waitcnt vmcnt(12)
    s_waitcnt vmcnt(11)
    v_mfma_f32_16x16x32_bf16 v[52:55], v[188:191], v[152:155], v[52:55]
    ds_read_b64_tr_b16 v[140:141], v12 offset:5184
    ds_read_b64_tr_b16 v[142:143], v12 offset:7744
    v_mfma_f32_16x16x32_bf16 v[56:59], v[192:195], v[152:155], v[56:59]
    buffer_load_dwordx4 v[16:19], v213, s[48:51], s10 offen offset:3072 sc1
    s_waitcnt lgkmcnt(10)
    v_mfma_f32_16x16x32_bf16 v[60:63], v[188:191], v[156:159], v[60:63]
    v_mfma_f32_16x16x32_bf16 v[64:67], v[192:195], v[156:159], v[64:67]
    ds_read_b64_tr_b16 v[144:145], v12 offset:5216
    ds_read_b64_tr_b16 v[146:147], v12 offset:7776
    v_mfma_f32_16x16x32_bf16 v[68:71], v[188:191], v[160:163], v[68:71]
    ds_read_b64_tr_b16 v[148:149], v12 offset:5248
    ds_read_b64_tr_b16 v[150:151], v12 offset:7808
    v_mfma_f32_16x16x32_bf16 v[72:75], v[192:195], v[160:163], v[72:75]
    buffer_load_dwordx4 v[20:23], v213, s[48:51], s11 offen offset:0 sc1
    s_waitcnt lgkmcnt(10)
    v_mfma_f32_16x16x32_bf16 v[76:79], v[188:191], v[164:167], v[76:79]
    ds_read_b64_tr_b16 v[152:153], v13 offset:0
    ds_read_b64_tr_b16 v[154:155], v13 offset:2560
    v_mfma_f32_16x16x32_bf16 v[80:83], v[192:195], v[164:167], v[80:83]
    ds_read_b64_tr_b16 v[156:157], v13 offset:32
    ds_read_b64_tr_b16 v[158:159], v13 offset:2592
    v_mfma_f32_16x16x32_bf16 v[84:87], v[188:191], v[168:171], v[84:87]
    buffer_load_dwordx4 v[24:27], v213, s[48:51], s11 offen offset:1024 sc1
    s_waitcnt vmcnt(13)
    v_mfma_f32_16x16x32_bf16 v[88:91], v[192:195], v[168:171], v[88:91]
    s_waitcnt vmcnt(12)
    s_waitcnt lgkmcnt(10)
    v_mfma_f32_16x16x32_bf16 v[52:55], v[196:199], v[132:135], v[52:55]
    v_mfma_f32_16x16x32_bf16 v[56:59], v[200:203], v[132:135], v[56:59]
    ds_read_b64_tr_b16 v[160:161], v13 offset:64
    ds_read_b64_tr_b16 v[162:163], v13 offset:2624
    v_mfma_f32_16x16x32_bf16 v[60:63], v[196:199], v[136:139], v[60:63]
    ds_read_b64_tr_b16 v[164:165], v13 offset:96
    ds_read_b64_tr_b16 v[166:167], v13 offset:2656
    v_mfma_f32_16x16x32_bf16 v[64:67], v[200:203], v[136:139], v[64:67]
    buffer_load_dwordx4 v[28:31], v213, s[48:51], s11 offen offset:2048 sc1
    s_waitcnt lgkmcnt(10)
    v_mfma_f32_16x16x32_bf16 v[68:71], v[196:199], v[140:143], v[68:71]
    v_mfma_f32_16x16x32_bf16 v[72:75], v[200:203], v[140:143], v[72:75]
    ds_read_b64_tr_b16 v[168:169], v13 offset:128
    ds_read_b64_tr_b16 v[170:171], v13 offset:2688
    v_mfma_f32_16x16x32_bf16 v[76:79], v[196:199], v[144:147], v[76:79]
    ds_read_b64_tr_b16 v[132:133], v13 offset:5120
    ds_read_b64_tr_b16 v[134:135], v13 offset:7680
    v_mfma_f32_16x16x32_bf16 v[80:83], v[200:203], v[144:147], v[80:83]
    buffer_load_dwordx4 v[32:35], v213, s[48:51], s11 offen offset:3072 sc1
    s_waitcnt lgkmcnt(10)
    v_mfma_f32_16x16x32_bf16 v[84:87], v[196:199], v[148:151], v[84:87]
    ds_read_b64_tr_b16 v[136:137], v13 offset:5152
    ds_read_b64_tr_b16 v[138:139], v13 offset:7712
    v_mfma_f32_16x16x32_bf16 v[88:91], v[200:203], v[148:151], v[88:91]
    s_waitcnt vmcnt(13)
    s_waitcnt vmcnt(12)
    v_mfma_f32_16x16x32_bf16 v[52:55], v[216:219], v[152:155], v[52:55]
    ds_read_b64_tr_b16 v[140:141], v13 offset:5184
    ds_read_b64_tr_b16 v[142:143], v13 offset:7744
    v_mfma_f32_16x16x32_bf16 v[56:59], v[220:223], v[152:155], v[56:59]
    buffer_load_dwordx4 v[108:111], v1, s[48:51], s10 offen offset:0 sc1
    s_waitcnt lgkmcnt(10)
    v_mfma_f32_16x16x32_bf16 v[60:63], v[216:219], v[156:159], v[60:63]
    v_mfma_f32_16x16x32_bf16 v[64:67], v[220:223], v[156:159], v[64:67]
    ds_read_b64_tr_b16 v[144:145], v13 offset:5216
    ds_read_b64_tr_b16 v[146:147], v13 offset:7776
    v_mfma_f32_16x16x32_bf16 v[68:71], v[216:219], v[160:163], v[68:71]
    ds_read_b64_tr_b16 v[148:149], v13 offset:5248
    ds_read_b64_tr_b16 v[150:151], v13 offset:7808
    v_mfma_f32_16x16x32_bf16 v[72:75], v[220:223], v[160:163], v[72:75]
    buffer_load_dwordx4 v[112:115], v1, s[48:51], s11 offen offset:0 sc1
    s_waitcnt lgkmcnt(10)
    v_mfma_f32_16x16x32_bf16 v[76:79], v[216:219], v[164:167], v[76:79]
    ds_read_b64_tr_b16 v[152:153], v12 offset:10240
    ds_read_b64_tr_b16 v[154:155], v13 offset:10240
    v_mfma_f32_16x16x32_bf16 v[80:83], v[220:223], v[164:167], v[80:83]
    ds_read_b64_tr_b16 v[156:157], v12 offset:10272
    ds_read_b64_tr_b16 v[158:159], v13 offset:10272
    v_mfma_f32_16x16x32_bf16 v[84:87], v[216:219], v[168:171], v[84:87]
    buffer_load_dwordx4 v[36:39], v213, s[48:51], s5 offen offset:0 sc1
    s_waitcnt vmcnt(14)
    v_mfma_f32_16x16x32_bf16 v[88:91], v[220:223], v[168:171], v[88:91]
    s_waitcnt vmcnt(13)
    s_waitcnt lgkmcnt(10)
    v_mfma_f32_16x16x32_bf16 v[52:55], v[224:227], v[132:135], v[52:55]
    ds_read_b64_tr_b16 v[160:161], v12 offset:10304
    v_mfma_f32_16x16x32_bf16 v[56:59], v[228:231], v[132:135], v[56:59]
    ds_read_b64_tr_b16 v[162:163], v13 offset:10304
    ds_read_b64_tr_b16 v[164:165], v12 offset:10336
    v_mfma_f32_16x16x32_bf16 v[60:63], v[224:227], v[136:139], v[60:63]
    ds_read_b64_tr_b16 v[166:167], v13 offset:10336
    buffer_load_dwordx4 v[40:43], v213, s[48:51], s5 offen offset:1024 sc1
    v_mfma_f32_16x16x32_bf16 v[64:67], v[228:231], v[136:139], v[64:67]
    s_waitcnt lgkmcnt(10)
    ds_read_b64_tr_b16 v[168:169], v12 offset:10368
    v_mfma_f32_16x16x32_bf16 v[68:71], v[224:227], v[140:143], v[68:71]
    ds_read_b64_tr_b16 v[170:171], v13 offset:10368
    s_waitcnt vmcnt(12)
    v_mfma_f32_16x16x32_bf16 v[72:75], v[228:231], v[140:143], v[72:75]
    v_swap_b32 v102, v104
    v_swap_b32 v103, v105
    v_mfma_f32_16x16x32_bf16 v[76:79], v[224:227], v[144:147], v[76:79]
    ds_read_b64_tr_b16 v[132:133], v14 offset:0
    ds_read_b64_tr_b16 v[134:135], v14 offset:2560
    v_mfma_f32_16x16x32_bf16 v[80:83], v[228:231], v[144:147], v[80:83]
    buffer_load_dwordx4 v[116:119], v213, s[48:51], s5 offen offset:2048 sc1
    s_waitcnt lgkmcnt(10)
    v_mfma_f32_16x16x32_bf16 v[84:87], v[224:227], v[148:151], v[84:87]
    v_mfma_f32_16x16x32_bf16 v[88:91], v[228:231], v[148:151], v[88:91]
    ds_read_b64_tr_b16 v[136:137], v14 offset:32
    ds_read_b64_tr_b16 v[138:139], v14 offset:2592
    v_mfma_f32_16x16x32_bf16 v[52:55], v[100:103], v[152:155], v[52:55]
    ds_read_b64_tr_b16 v[140:141], v14 offset:64
    ds_read_b64_tr_b16 v[142:143], v14 offset:2624
    v_mfma_f32_16x16x32_bf16 v[56:59], v[104:107], v[152:155], v[56:59]
    buffer_load_dwordx4 v[120:123], v213, s[48:51], s5 offen offset:3072 sc1
    s_waitcnt lgkmcnt(10)
    v_mfma_f32_16x16x32_bf16 v[60:63], v[100:103], v[156:159], v[60:63]
    v_mfma_f32_16x16x32_bf16 v[64:67], v[104:107], v[156:159], v[64:67]
    ds_read_b64_tr_b16 v[144:145], v14 offset:96
    ds_read_b64_tr_b16 v[146:147], v14 offset:2656
    v_mfma_f32_16x16x32_bf16 v[68:71], v[100:103], v[160:163], v[68:71]
    ds_read_b64_tr_b16 v[148:149], v14 offset:128
    ds_read_b64_tr_b16 v[150:151], v14 offset:2688
    v_mfma_f32_16x16x32_bf16 v[72:75], v[104:107], v[160:163], v[72:75]
    buffer_load_dwordx4 v[48:51], v1, s[48:51], s5 offen offset:0 sc1
    s_waitcnt lgkmcnt(10)
    v_mfma_f32_16x16x32_bf16 v[76:79], v[100:103], v[164:167], v[76:79]
    ds_read_b64_tr_b16 v[152:153], v14 offset:5120
    v_mfma_f32_16x16x32_bf16 v[80:83], v[104:107], v[164:167], v[80:83]
    ds_read_b64_tr_b16 v[154:155], v14 offset:7680
    ds_read_b64_tr_b16 v[156:157], v14 offset:5152
    v_mfma_f32_16x16x32_bf16 v[84:87], v[100:103], v[168:171], v[84:87]
    ds_read_b64_tr_b16 v[158:159], v14 offset:7712
    s_waitcnt vmcnt(14)
    v_mfma_f32_16x16x32_bf16 v[88:91], v[104:107], v[168:171], v[88:91]
    s_waitcnt vmcnt(13)
    s_waitcnt lgkmcnt(10)
    v_mfma_f32_16x16x32_bf16 v[52:55], v[232:235], v[132:135], v[52:55]
    v_mfma_f32_16x16x32_bf16 v[56:59], v[236:239], v[132:135], v[56:59]
    ds_read_b64_tr_b16 v[160:161], v14 offset:5184
    ds_read_b64_tr_b16 v[162:163], v14 offset:7744
    v_mfma_f32_16x16x32_bf16 v[60:63], v[232:235], v[136:139], v[60:63]
    ds_read_b64_tr_b16 v[164:165], v14 offset:5216
    v_mfma_f32_16x16x32_bf16 v[64:67], v[236:239], v[136:139], v[64:67]
    ds_read_b64_tr_b16 v[166:167], v14 offset:7776
    s_waitcnt lgkmcnt(10)
    v_mfma_f32_16x16x32_bf16 v[68:71], v[232:235], v[140:143], v[68:71]
    v_mfma_f32_16x16x32_bf16 v[72:75], v[236:239], v[140:143], v[72:75]
    ds_read_b64_tr_b16 v[168:169], v14 offset:5248
    ds_read_b64_tr_b16 v[170:171], v14 offset:7808
    v_mfma_f32_16x16x32_bf16 v[76:79], v[232:235], v[144:147], v[76:79]
    ds_read_b64_tr_b16 v[132:133], v15 offset:0
    v_mfma_f32_16x16x32_bf16 v[80:83], v[236:239], v[144:147], v[80:83]
    ds_read_b64_tr_b16 v[134:135], v15 offset:2560
    s_waitcnt lgkmcnt(10)
    v_mfma_f32_16x16x32_bf16 v[84:87], v[232:235], v[148:151], v[84:87]
    ds_read_b64_tr_b16 v[136:137], v15 offset:32
    ds_read_b64_tr_b16 v[138:139], v15 offset:2592
    v_mfma_f32_16x16x32_bf16 v[88:91], v[236:239], v[148:151], v[88:91]
    s_waitcnt vmcnt(12)
    s_waitcnt vmcnt(11)
    v_mfma_f32_16x16x32_bf16 v[52:55], v[240:243], v[152:155], v[52:55]
    ds_read_b64_tr_b16 v[140:141], v15 offset:64
    v_mfma_f32_16x16x32_bf16 v[56:59], v[16:19], v[152:155], v[56:59]
    ds_read_b64_tr_b16 v[142:143], v15 offset:2624
    s_waitcnt lgkmcnt(10)
    v_mfma_f32_16x16x32_bf16 v[60:63], v[240:243], v[156:159], v[60:63]
    v_mfma_f32_16x16x32_bf16 v[64:67], v[16:19], v[156:159], v[64:67]
    ds_read_b64_tr_b16 v[144:145], v15 offset:96
    ds_read_b64_tr_b16 v[146:147], v15 offset:2656
    v_mfma_f32_16x16x32_bf16 v[68:71], v[240:243], v[160:163], v[68:71]
    ds_read_b64_tr_b16 v[148:149], v15 offset:128
    v_mfma_f32_16x16x32_bf16 v[72:75], v[16:19], v[160:163], v[72:75]
    ds_read_b64_tr_b16 v[150:151], v15 offset:2688
    s_waitcnt lgkmcnt(10)
    v_mfma_f32_16x16x32_bf16 v[76:79], v[240:243], v[164:167], v[76:79]
    ds_read_b64_tr_b16 v[152:153], v15 offset:5120
    v_mfma_f32_16x16x32_bf16 v[80:83], v[16:19], v[164:167], v[80:83]
    ds_read_b64_tr_b16 v[154:155], v15 offset:7680
    ds_read_b64_tr_b16 v[156:157], v14 offset:10240
    v_mfma_f32_16x16x32_bf16 v[84:87], v[240:243], v[168:171], v[84:87]
    ds_read_b64_tr_b16 v[158:159], v15 offset:10240
    s_waitcnt vmcnt(10)
    v_mfma_f32_16x16x32_bf16 v[88:91], v[16:19], v[168:171], v[88:91]
    s_waitcnt vmcnt(9)
    s_waitcnt lgkmcnt(10)
    v_mfma_f32_16x16x32_bf16 v[52:55], v[20:23], v[132:135], v[52:55]
    v_mfma_f32_16x16x32_bf16 v[56:59], v[24:27], v[132:135], v[56:59]
    ds_read_b64_tr_b16 v[160:161], v9 offset:0
    ds_read_b64_tr_b16 v[162:163], v9 offset:2560
    v_mfma_f32_16x16x32_bf16 v[60:63], v[20:23], v[136:139], v[60:63]
    ds_read_b64_tr_b16 v[164:165], v9 offset:5120
    v_mfma_f32_16x16x32_bf16 v[64:67], v[24:27], v[136:139], v[64:67]
    ds_read_b64_tr_b16 v[166:167], v9 offset:7680
    s_waitcnt lgkmcnt(10)
    v_mfma_f32_16x16x32_bf16 v[68:71], v[20:23], v[140:143], v[68:71]
    ds_read_b64_tr_b16 v[168:169], v8 offset:10240
    ds_read_b64_tr_b16 v[170:171], v9 offset:10240
    v_mfma_f32_16x16x32_bf16 v[72:75], v[24:27], v[140:143], v[72:75]
    ds_read_b64_tr_b16 v[132:133], v15 offset:5152
    ds_read_b64_tr_b16 v[134:135], v15 offset:7712
    v_mfma_f32_16x16x32_bf16 v[76:79], v[20:23], v[144:147], v[76:79]
    s_waitcnt vmcnt(5)
    v_swap_b32 v110, v112
    v_mfma_f32_16x16x32_bf16 v[80:83], v[24:27], v[144:147], v[80:83]
    v_swap_b32 v111, v113
    s_waitcnt lgkmcnt(10)
    v_mfma_f32_16x16x32_bf16 v[84:87], v[20:23], v[148:151], v[84:87]
    ds_read_b64_tr_b16 v[136:137], v14 offset:10272
    v_mfma_f32_16x16x32_bf16 v[88:91], v[24:27], v[148:151], v[88:91]
    ds_read_b64_tr_b16 v[138:139], v15 offset:10272
    ds_read_b64_tr_b16 v[140:141], v9 offset:32
    v_mfma_f32_16x16x32_bf16 v[52:55], v[28:31], v[152:155], v[52:55]
    ds_read_b64_tr_b16 v[142:143], v9 offset:2592
    s_waitcnt lgkmcnt(10)
    v_mfma_f32_16x16x32_bf16 v[56:59], v[32:35], v[152:155], v[56:59]
    ds_read_b64_tr_b16 v[144:145], v9 offset:5152
    ds_read_b64_tr_b16 v[146:147], v9 offset:7712
    v_mfma_f32_16x16x32_bf16 v[52:55], v[108:111], v[156:159], v[52:55]
    s_waitcnt vmcnt(4)
    s_waitcnt vmcnt(3)
    v_mfma_f32_16x16x32_bf16 v[56:59], v[112:115], v[156:159], v[56:59]
    s_waitcnt vmcnt(0)
    v_swap_b32 v46, v48
    v_mfma_f32_16x16x32_bf16 v[52:55], v[36:39], v[160:163], v[52:55]
    v_swap_b32 v47, v49
    ds_read_b64_tr_b16 v[148:149], v8 offset:10272
    v_mfma_f32_16x16x32_bf16 v[56:59], v[40:43], v[160:163], v[56:59]
    ds_read_b64_tr_b16 v[150:151], v9 offset:10272
    s_waitcnt lgkmcnt(10)
    v_mfma_f32_16x16x32_bf16 v[52:55], v[116:119], v[164:167], v[52:55]
    v_mfma_f32_16x16x32_bf16 v[56:59], v[120:123], v[164:167], v[56:59]
    ds_read_b64_tr_b16 v[152:153], v15 offset:5184
    ds_read_b64_tr_b16 v[154:155], v15 offset:7744
    v_mfma_f32_16x16x32_bf16 v[52:55], v[44:47], v[168:171], v[52:55]
    ds_read_b64_tr_b16 v[156:157], v14 offset:10304
    ds_read_b64_tr_b16 v[158:159], v15 offset:10304
    v_mfma_f32_16x16x32_bf16 v[56:59], v[48:51], v[168:171], v[56:59]
    s_waitcnt lgkmcnt(10)
    ds_read_b64_tr_b16 v[160:161], v9 offset:64
    v_mfma_f32_16x16x32_bf16 v[60:63], v[28:31], v[132:135], v[60:63]
    ds_read_b64_tr_b16 v[162:163], v9 offset:2624
    ds_read_b64_tr_b16 v[164:165], v9 offset:5184
    v_mfma_f32_16x16x32_bf16 v[64:67], v[32:35], v[132:135], v[64:67]
    ds_read_b64_tr_b16 v[166:167], v9 offset:7744
    s_waitcnt lgkmcnt(10)
    v_mfma_f32_16x16x32_bf16 v[60:63], v[108:111], v[136:139], v[60:63]
    ds_read_b64_tr_b16 v[168:169], v8 offset:10304
    ds_read_b64_tr_b16 v[170:171], v9 offset:10304
    v_mfma_f32_16x16x32_bf16 v[64:67], v[112:115], v[136:139], v[64:67]
    buffer_store_dword v52, v214, s[44:47], s94 offen offset:0 sc1
    buffer_store_dword v53, v214, s[44:47], s95 offen offset:0 sc1
    v_mfma_f32_16x16x32_bf16 v[60:63], v[36:39], v[140:143], v[60:63]
    buffer_store_dword v54, v214, s[44:47], s96 offen offset:0 sc1
    ds_read_b64_tr_b16 v[132:133], v15 offset:5216
    v_mfma_f32_16x16x32_bf16 v[64:67], v[40:43], v[140:143], v[64:67]
    ds_read_b64_tr_b16 v[134:135], v15 offset:7776
    buffer_store_dword v55, v214, s[44:47], s97 offen offset:0 sc1
    v_mfma_f32_16x16x32_bf16 v[60:63], v[116:119], v[144:147], v[60:63]
    buffer_store_dword v56, v214, s[44:47], s98 offen offset:0 sc1
    buffer_store_dword v57, v214, s[44:47], s99 offen offset:0 sc1
    v_mfma_f32_16x16x32_bf16 v[64:67], v[120:123], v[144:147], v[64:67]
    s_waitcnt lgkmcnt(10)
    ds_read_b64_tr_b16 v[136:137], v14 offset:10336
    v_mfma_f32_16x16x32_bf16 v[60:63], v[44:47], v[148:151], v[60:63]
    ds_read_b64_tr_b16 v[138:139], v15 offset:10336
    buffer_store_dword v58, v214, s[44:47], s100 offen offset:0 sc1
    v_mfma_f32_16x16x32_bf16 v[64:67], v[48:51], v[148:151], v[64:67]
    buffer_store_dword v59, v214, s[44:47], s101 offen offset:0 sc1
    ds_read_b64_tr_b16 v[140:141], v9 offset:96
    v_mfma_f32_16x16x32_bf16 v[68:71], v[28:31], v[152:155], v[68:71]
    ds_read_b64_tr_b16 v[142:143], v9 offset:2656
    s_waitcnt lgkmcnt(10)
    v_mfma_f32_16x16x32_bf16 v[72:75], v[32:35], v[152:155], v[72:75]
    ds_read_b64_tr_b16 v[144:145], v9 offset:5216
    ds_read_b64_tr_b16 v[146:147], v9 offset:7776
    v_mfma_f32_16x16x32_bf16 v[68:71], v[108:111], v[156:159], v[68:71]
    ds_read_b64_tr_b16 v[148:149], v8 offset:10336
    ds_read_b64_tr_b16 v[150:151], v9 offset:10336
    v_mfma_f32_16x16x32_bf16 v[72:75], v[112:115], v[156:159], v[72:75]
    buffer_store_dword v60, v214, s[44:47], s94 offen offset:64 sc1
    buffer_store_dword v61, v214, s[44:47], s95 offen offset:64 sc1
    v_mfma_f32_16x16x32_bf16 v[68:71], v[36:39], v[160:163], v[68:71]
    buffer_store_dword v62, v214, s[44:47], s96 offen offset:64 sc1
    s_waitcnt lgkmcnt(10)
    v_mfma_f32_16x16x32_bf16 v[72:75], v[40:43], v[160:163], v[72:75]
    ds_read_b64_tr_b16 v[152:153], v15 offset:5248
    ds_read_b64_tr_b16 v[154:155], v15 offset:7808
    v_mfma_f32_16x16x32_bf16 v[68:71], v[116:119], v[164:167], v[68:71]
    buffer_store_dword v63, v214, s[44:47], s97 offen offset:64 sc1
    buffer_store_dword v64, v214, s[44:47], s98 offen offset:64 sc1
    v_mfma_f32_16x16x32_bf16 v[72:75], v[120:123], v[164:167], v[72:75]
    buffer_store_dword v65, v214, s[44:47], s99 offen offset:64 sc1
    ds_read_b64_tr_b16 v[156:157], v14 offset:10368
    v_mfma_f32_16x16x32_bf16 v[68:71], v[44:47], v[168:171], v[68:71]
    ds_read_b64_tr_b16 v[158:159], v15 offset:10368
    buffer_store_dword v66, v214, s[44:47], s100 offen offset:64 sc1
    v_mfma_f32_16x16x32_bf16 v[72:75], v[48:51], v[168:171], v[72:75]
    buffer_store_dword v67, v214, s[44:47], s101 offen offset:64 sc1
    s_waitcnt lgkmcnt(10)
    v_mfma_f32_16x16x32_bf16 v[76:79], v[28:31], v[132:135], v[76:79]
    v_mfma_f32_16x16x32_bf16 v[80:83], v[32:35], v[132:135], v[80:83]
    ds_read_b64_tr_b16 v[160:161], v9 offset:128
    ds_read_b64_tr_b16 v[162:163], v9 offset:2688
    v_mfma_f32_16x16x32_bf16 v[76:79], v[108:111], v[136:139], v[76:79]
    ds_read_b64_tr_b16 v[164:165], v9 offset:5248
    ds_read_b64_tr_b16 v[166:167], v9 offset:7808
    v_mfma_f32_16x16x32_bf16 v[80:83], v[112:115], v[136:139], v[80:83]
    s_waitcnt lgkmcnt(10)
    ds_read_b64_tr_b16 v[168:169], v8 offset:10368
    v_mfma_f32_16x16x32_bf16 v[76:79], v[36:39], v[140:143], v[76:79]
    ds_read_b64_tr_b16 v[170:171], v9 offset:10368
    buffer_store_dword v68, v214, s[44:47], s94 offen offset:128 sc1
    v_mfma_f32_16x16x32_bf16 v[80:83], v[40:43], v[140:143], v[80:83]
    buffer_store_dword v69, v214, s[44:47], s95 offen offset:128 sc1
    buffer_store_dword v70, v214, s[44:47], s96 offen offset:128 sc1
    v_mfma_f32_16x16x32_bf16 v[76:79], v[116:119], v[144:147], v[76:79]
    buffer_store_dword v71, v214, s[44:47], s97 offen offset:128 sc1
    buffer_store_dword v72, v214, s[44:47], s98 offen offset:128 sc1
    v_mfma_f32_16x16x32_bf16 v[80:83], v[120:123], v[144:147], v[80:83]
    buffer_store_dword v73, v214, s[44:47], s99 offen offset:128 sc1
    s_waitcnt lgkmcnt(8)
    v_mfma_f32_16x16x32_bf16 v[76:79], v[44:47], v[148:151], v[76:79]
    v_mfma_f32_16x16x32_bf16 v[80:83], v[48:51], v[148:151], v[80:83]
    buffer_store_dword v74, v214, s[44:47], s100 offen offset:128 sc1
    buffer_store_dword v75, v214, s[44:47], s101 offen offset:128 sc1
    v_mfma_f32_16x16x32_bf16 v[84:87], v[28:31], v[152:155], v[84:87]
    v_mfma_f32_16x16x32_bf16 v[88:91], v[32:35], v[152:155], v[88:91]
    s_waitcnt lgkmcnt(4)
    v_mfma_f32_16x16x32_bf16 v[84:87], v[108:111], v[156:159], v[84:87]
    v_mfma_f32_16x16x32_bf16 v[88:91], v[112:115], v[156:159], v[88:91]
    v_mfma_f32_16x16x32_bf16 v[84:87], v[36:39], v[160:163], v[84:87]
    buffer_store_dword v76, v214, s[44:47], s94 offen offset:192 sc1
    buffer_store_dword v77, v214, s[44:47], s95 offen offset:192 sc1
    v_mfma_f32_16x16x32_bf16 v[88:91], v[40:43], v[160:163], v[88:91]
    buffer_store_dword v78, v214, s[44:47], s96 offen offset:192 sc1
    s_waitcnt lgkmcnt(0)
    v_mfma_f32_16x16x32_bf16 v[84:87], v[116:119], v[164:167], v[84:87]
    v_mfma_f32_16x16x32_bf16 v[88:91], v[120:123], v[164:167], v[88:91]
    buffer_store_dword v79, v214, s[44:47], s97 offen offset:192 sc1
    buffer_store_dword v80, v214, s[44:47], s98 offen offset:192 sc1
    v_mfma_f32_16x16x32_bf16 v[84:87], v[44:47], v[168:171], v[84:87]
    buffer_store_dword v81, v214, s[44:47], s99 offen offset:192 sc1
    buffer_store_dword v82, v214, s[44:47], s100 offen offset:192 sc1
    v_mfma_f32_16x16x32_bf16 v[88:91], v[48:51], v[168:171], v[88:91]
    buffer_store_dword v83, v214, s[44:47], s101 offen offset:192 sc1
    s_nop 3
    buffer_store_dword v84, v214, s[44:47], s94 offen offset:256 sc1
    buffer_store_dword v85, v214, s[44:47], s95 offen offset:256 sc1
    buffer_store_dword v86, v214, s[44:47], s96 offen offset:256 sc1
    buffer_store_dword v87, v214, s[44:47], s97 offen offset:256 sc1
    buffer_store_dword v88, v214, s[44:47], s98 offen offset:256 sc1
    buffer_store_dword v89, v214, s[44:47], s99 offen offset:256 sc1
    buffer_store_dword v90, v214, s[44:47], s100 offen offset:256 sc1
    buffer_store_dword v91, v214, s[44:47], s101 offen offset:256 sc1
    s_or_b32 s59, s53, s55
    s_cmp_lg_u32 s59, 0
    s_cbranch_scc1 L_noep_32
    s_cmp_lg_u32 s52, 0
    s_cbranch_scc1 L_noep_32
    s_lshl_b32 s59, s35, 8
    v_mov_b32 v250, s56
    v_mov_b32 v251, 0
    s_mov_b64 exec, 1
    buffer_store_dword v250, v251, s[48:51], s59 offen sc1
    s_mov_b64 exec, -1
L_noep_32:
    s_endpgm
L_BL:
    s_lshl_b32 s59, s52, 2
    s_add_u32 s59, s59, s55
    s_mul_i32 s59, s59, 40960
    v_lshrrev_b32 v250, 4, v0
    v_and_b32 v251, 7, v0
    v_xor_b32 v250, v250, v251
    v_lshlrev_b32 v250, 4, v250
    v_lshrrev_b32 v251, 5, v0
    v_lshlrev_b32 v251, 3, v251
    v_bfe_u32 v252, v0, 3, 1
    v_lshl_add_u32 v251, v252, 2, v251
    v_bfe_u32 v252, v0, 4, 1
    v_add_u32 v251, v251, v252
    v_mul_u32_u24 v251, 1280, v251
    v_add_u32 v251, s59, v251
    v_xor_b32 v252, 64, v250
    v_add_u32 v250, v250, v251
    v_add_u32 v252, v252, v251
    v_add_u32 v1, 0, v250
    v_add_u32 v2, 20480, v252
    v_add_u32 v3, 2560, v250
    v_add_u32 v4, 23040, v252
    s_add_u32 s57, s54, s53
    s_mul_i32 s59, s57, 86
    s_lshr_b32 s59, s59, 8
    s_mul_i32 s59, s59, 3
    s_sub_u32 s57, s57, s59
    s_mul_i32 s57, s57, 10
    s_add_u32 s57, s57, 1
    s_mul_i32 s57, s57, 86
    s_lshr_b32 s57, s57, 8
    s_lshr_b32 s59, s52, 2
    s_add_u32 s57, s57, s59
    s_cmp_ge_u32 s57, 10
    s_cselect_b32 s59, 10, 0
    s_sub_u32 s57, s57, s59
    s_mov_b32 s74, s53
    s_mov_b32 s75, 1
    s_xor_b32 s90, s53, s54
    s_andn2_b32 s90, 1, s90
    s_bitcmp1_b32 s54, 0
    s_cselect_b32 s75, -1, 1
    s_cselect_b32 s59, 10, 0
    s_add_u32 s74, s74, s59
    s_and_b32 s60, s55, 1
    s_mul_i32 s59, s60, 40
    s_mul_i32 s61, s53, 80
    s_add_u32 s59, s59, s61
    s_mul_i32 s59, s59, 1280
    s_lshl_b32 s60, s60, 6
    v_lshrrev_b32 v250, 4, v0
    v_and_b32 v251, 7, v0
    v_xor_b32 v250, v250, v251
    v_lshlrev_b32 v250, 4, v250
    v_xor_b32 v250, s60, v250
    v_xor_b32 v252, 64, v250
    v_lshrrev_b32 v251, 3, v0
    v_mul_u32_u24 v251, 1280, v251
    v_add_u32 v251, s59, v251
    v_add_u32 v250, v250, v251
    v_add_u32 v252, v252, v251
    s_mul_i32 s61, s53, 0xffffb000
    s_mul_i32 s62, s53, 0xfffec000
    s_add_u32 s62, s62, 573440
    s_bitcmp1_b32 s55, 0
    s_cselect_b32 s62, s62, s61
    v_add_u32 v44, 0, v250
    v_add_u32 v5, s61, v44
    v_add_u32 v45, 10240, v252
    v_add_u32 v6, s61, v45
    v_add_u32 v46, 20480, v250
    v_add_u32 v7, s61, v46
    v_add_u32 v47, 30720, v252
    v_add_u32 v8, s62, v47
    v_add_u32 v48, 40960, v250
    v_add_u32 v9, s62, v48
    s_lshl_b32 s72, s55, 12
    s_mul_i32 s73, s55, 5120
    s_mov_b32 s58, 16384
    s_waitcnt lgkmcnt(0)
    s_mov_b32 s36, s10
    s_mov_b32 s37, s11
    s_mov_b32 s38, 2621440
    s_mov_b32 s39, 0x20000
    s_cmp_ge_u32 s55, 2
    s_cselect_b32 s40, s18, s16
    s_cselect_b32 s41, s19, s17
    s_mov_b32 s42, 819200
    s_mov_b32 s43, 0x20000
    s_cselect_b32 s44, s22, s20
    s_cselect_b32 s45, s23, s21
    s_mov_b32 s46, 819200
    s_mov_b32 s47, 0x20000
    s_lshl_b32 s59, s57, 7
    s_add_u32 s61, s58, s72
    s_add_u32 s62, s58, s73
    s_add_u32 s62, s62, 16384
    s_add_u32 m0, s61, 0
    s_nop 0
    buffer_load_dwordx4 v1, s[36:39], s59 offen lds
    s_add_u32 m0, s61, 1024
    s_nop 0
    buffer_load_dwordx4 v2, s[36:39], s59 offen lds
    s_add_u32 m0, s61, 2048
    s_nop 0
    buffer_load_dwordx4 v3, s[36:39], s59 offen lds
    s_add_u32 m0, s61, 3072
    s_nop 0
    buffer_load_dwordx4 v4, s[36:39], s59 offen lds
    s_add_u32 m0, s62, 0
    s_nop 0
    buffer_load_dwordx4 v5, s[40:43], s59 offen lds
    s_add_u32 m0, s62, 1024
    s_nop 0
    buffer_load_dwordx4 v6, s[40:43], s59 offen lds
    s_add_u32 m0, s62, 2048
    s_nop 0
    buffer_load_dwordx4 v7, s[40:43], s59 offen lds
    s_add_u32 m0, s62, 3072
    s_nop 0
    buffer_load_dwordx4 v8, s[40:43], s59 offen lds
    s_add_u32 m0, s62, 4096
    s_nop 0
    buffer_load_dwordx4 v9, s[40:43], s59 offen lds
    s_add_u32 s57, s57, 1
    s_cmp_eq_u32 s57, 10
    s_cselect_b32 s57, 0, s57
    s_add_u32 s58, s58, 36864
    s_cmp_eq_u32 s58, 163840
    s_cselect_b32 s58, 16384, s58
    s_lshl_b32 s59, s35, 8
    s_load_dword s56, s[32:33], s59
    s_mov_b32 s48, s32
    s_mov_b32 s49, s33
    s_mov_b32 s50, 268435456
    s_mov_b32 s51, 0x20000
    s_mul_i32 s59, s53, 160
    v_add_u32 v250, 0, v0
    v_mul_u32_u24 v251, 6554, v250
    v_lshrrev_b32 v251, 16, v251
    v_mad_i32_i24 v252, v251, -10, v250
    v_mul_u32_u24 v251, 1280, v251
    v_lshl_add_u32 v251, v252, 4, v251
    v_add_u32 v13, s59, v251
    v_add_u32 v250, 64, v0
    v_mul_u32_u24 v251, 6554, v250
    v_lshrrev_b32 v251, 16, v251
    v_mad_i32_i24 v252, v251, -10, v250
    v_mul_u32_u24 v251, 1280, v251
    v_lshl_add_u32 v251, v252, 4, v251
    v_add_u32 v14, s59, v251
    v_add_u32 v250, 128, v0
    v_mul_u32_u24 v251, 6554, v250
    v_lshrrev_b32 v251, 16, v251
    v_mad_i32_i24 v252, v251, -10, v250
    v_mul_u32_u24 v251, 1280, v251
    v_lshl_add_u32 v251, v252, 4, v251
    v_add_u32 v15, s59, v251
    v_add_u32 v250, 192, v0
    v_mul_u32_u24 v251, 6554, v250
    v_lshrrev_b32 v251, 16, v251
    v_mad_i32_i24 v252, v251, -10, v250
    v_mul_u32_u24 v251, 1280, v251
    v_lshl_add_u32 v251, v252, 4, v251
    v_add_u32 v16, s59, v251
    v_add_u32 v250, 256, v0
    v_mul_u32_u24 v251, 6554, v250
    v_lshrrev_b32 v251, 16, v251
    v_mad_i32_i24 v252, v251, -10, v250
    v_mul_u32_u24 v251, 1280, v251
    v_lshl_add_u32 v251, v252, 4, v251
    v_add_u32 v17, s59, v251
    v_and_b32 v20, 15, v0
    v_mul_u32_u24 v20, 48, v20
    v_and_b32 v21, 0x30, v0
    v_add_u32 v20, v20, v21
    v_lshlrev_b32 v21, 4, v0
    s_lshl_b32 s91, s53, 4
    s_add_u32 s91, s91, s52
    s_mul_i32 s91, s91, 768
    s_add_u32 s91, s91, 65536
    s_mov_b32 s65, 1
L_ld_33:
    s_lshl_b32 s59, s57, 7
    s_add_u32 s61, s58, s72
    s_add_u32 s62, s58, s73
    s_add_u32 s62, s62, 16384
    s_add_u32 m0, s61, 0
    s_nop 0
    buffer_load_dwordx4 v1, s[36:39], s59 offen lds
    s_add_u32 m0, s61, 1024
    s_nop 0
    buffer_load_dwordx4 v2, s[36:39], s59 offen lds
    s_add_u32 m0, s61, 2048
    s_nop 0
    buffer_load_dwordx4 v3, s[36:39], s59 offen lds
    s_add_u32 m0, s61, 3072
    s_nop 0
    buffer_load_dwordx4 v4, s[36:39], s59 offen lds
    s_add_u32 m0, s62, 0
    s_nop 0
    buffer_load_dwordx4 v5, s[40:43], s59 offen lds
    s_add_u32 m0, s62, 1024
    s_nop 0
    buffer_load_dwordx4 v6, s[40:43], s59 offen lds
    s_add_u32 m0, s62, 2048
    s_nop 0
    buffer_load_dwordx4 v7, s[40:43], s59 offen lds
    s_add_u32 m0, s62, 3072
    s_nop 0
    buffer_load_dwordx4 v8, s[40:43], s59 offen lds
    s_add_u32 m0, s62, 4096
    s_nop 0
    buffer_load_dwordx4 v9, s[40:43], s59 offen lds
    s_add_u32 s57, s57, 1
    s_cmp_eq_u32 s57, 10
    s_cselect_b32 s57, 0, s57
    s_add_u32 s58, s58, 36864
    s_cmp_eq_u32 s58, 163840
    s_cselect_b32 s58, 16384, s58
    s_add_u32 s65, s65, 1
    s_waitcnt vmcnt(9)
    s_barrier
    s_cmp_lt_u32 s65, 10
    s_cbranch_scc1 L_ld_33
    s_waitcnt lgkmcnt(0)
    s_mul_i32 s56, s56, 1664525
    s_add_u32 s56, s56, 1013904223
    s_max_u32 s56, s56, 16
    s_lshr_b32 s59, s56, 0
    v_mov_b32 v40, s59
    s_lshr_b32 s59, s56, 8
    v_mov_b32 v41, s59
    s_lshr_b32 s59, s56, 16
    v_mov_b32 v42, s59
    s_lshr_b32 s59, s56, 24
    v_mov_b32 v43, s59
    s_mov_b32 s65, 2
L_bc_34:
    s_add_u32 s62, s65, s90
    s_cmp_eq_u32 s65, 0
    s_cselect_b32 s62, 0, s62
    s_cmp_eq_u32 s62, 10
    s_cselect_b32 s62, 1, s62
    s_mul_i32 s59, s75, s62
    s_add_u32 s59, s74, s59
    s_cmp_ge_u32 s59, 10
    s_cselect_b32 s60, 10, 0
    s_sub_u32 s59, s59, s60
    s_lshl_b32 s59, s59, 7
    s_andn2_b32 s60, 7, s65
    s_mul_i32 s60, s60, 20480
    s_add_u32 s60, s60, s73
    s_add_u32 m0, s60, 0
    s_nop 0
    buffer_load_dwordx4 v44, s[44:47], s59 offen lds
    s_add_u32 m0, s60, 1024
    s_nop 0
    buffer_load_dwordx4 v45, s[44:47], s59 offen lds
    s_add_u32 m0, s60, 2048
    s_nop 0
    buffer_load_dwordx4 v46, s[44:47], s59 offen lds
    s_add_u32 m0, s60, 3072
    s_nop 0
    buffer_load_dwordx4 v47, s[44:47], s59 offen lds
    s_add_u32 m0, s60, 4096
    s_nop 0
    buffer_load_dwordx4 v48, s[44:47], s59 offen lds
    s_waitcnt vmcnt(5)
    s_barrier
    s_cmp_lg_u32 s55, 3
    s_cbranch_scc1 L_nox_35
    s_lshl_b32 s59, s35, 4
    s_add_u32 s59, s59, s52
    s_lshl_b32 s59, s59, 10
    s_add_u32 s59, s59, 4096
    s_lshl_b32 s60, s53, 2
    s_add_u32 s59, s59, s60
    s_xor_b32 s60, s56, s76
    v_mov_b32 v250, s60
    v_mov_b32 v251, 512
    s_mov_b64 exec, 1
    buffer_store_dword v250, v251, s[48:51], s59 offen sc1
    s_mov_b64 exec, -1
L_nox_35:
    s_mov_b32 s65, 0
L_bc_36:
    s_add_u32 s62, s65, s90
    s_cmp_eq_u32 s65, 0
    s_cselect_b32 s62, 0, s62
    s_cmp_eq_u32 s62, 10
    s_cselect_b32 s62, 1, s62
    s_mul_i32 s59, s75, s62
    s_add_u32 s59, s74, s59
    s_cmp_ge_u32 s59, 10
    s_cselect_b32 s60, 10, 0
    s_sub_u32 s59, s59, s60
    s_lshl_b32 s59, s59, 7
    s_andn2_b32 s60, 7, s65
    s_mul_i32 s60, s60, 20480
    s_add_u32 s60, s60, s73
    s_add_u32 m0, s60, 0
    s_nop 0
    buffer_load_dwordx4 v44, s[44:47], s59 offen lds
    s_add_u32 m0, s60, 1024
    s_nop 0
    buffer_load_dwordx4 v45, s[44:47], s59 offen lds
    s_add_u32 m0, s60, 2048
    s_nop 0
    buffer_load_dwordx4 v46, s[44:47], s59 offen lds
    s_add_u32 m0, s60, 3072
    s_nop 0
    buffer_load_dwordx4 v47, s[44:47], s59 offen lds
    s_add_u32 m0, s60, 4096
    s_nop 0
    buffer_load_dwordx4 v48, s[44:47], s59 offen lds
    s_add_u32 s65, s65, 1
    s_cmp_lt_u32 s65, 2
    s_cbranch_scc1 L_bc_36
    s_barrier
    s_cmp_lg_u32 s55, 0
    s_cbranch_scc1 L_bnp_37
    s_mov_b32 exec_lo, 0xffffffff
    s_mov_b32 exec_hi, 0xffff
    ds_read_b128 v[24:27], v20 offset:10240
    ds_read_b128 v[28:31], v20 offset:11008
    ds_read_b128 v[32:35], v20 offset:11776
    ds_read_b128 v[36:39], v20 offset:12544
    s_movk_i32 s59, 0xff
    s_waitcnt lgkmcnt(0)
    v_pk_add_f32 v[24:25], v[24:25], v[28:29]
    v_pk_add_f32 v[32:33], v[32:33], v[36:37]
    v_pk_add_f32 v[26:27], v[26:27], v[30:31]
    v_pk_add_f32 v[34:35], v[34:35], v[38:39]
    v_pk_add_f32 v[24:25], v[24:25], v[32:33]
    v_pk_add_f32 v[26:27], v[26:27], v[34:35]
    v_bfi_b32 v24, s59, v40, v24
    v_bfi_b32 v25, s59, v41, v25
    v_bfi_b32 v26, s59, v42, v26
    v_bfi_b32 v27, s59, v43, v27
    buffer_store_dwordx4 v[24:27], v21, s[48:51], s91 offen sc1
    s_mov_b64 exec, -1
L_bnp_37:
    s_lshl_b32 s59, s52, 2
    s_add_u32 s59, s59, s55
    s_mul_i32 s59, s59, 40960
    s_add_u32 s60, s73, 20480
    s_add_u32 m0, s60, 0
    s_nop 0
    buffer_load_dwordx4 v13, s[36:39], s59 offen lds
    s_add_u32 m0, s60, 1024
    s_nop 0
    buffer_load_dwordx4 v14, s[36:39], s59 offen lds
    s_add_u32 m0, s60, 2048
    s_nop 0
    buffer_load_dwordx4 v15, s[36:39], s59 offen lds
    s_add_u32 m0, s60, 3072
    s_nop 0
    buffer_load_dwordx4 v16, s[36:39], s59 offen lds
    s_add_u32 m0, s60, 4096
    s_nop 0
    buffer_load_dwordx4 v17, s[36:39], s59 offen lds
    s_mov_b32 s65, 3
L_bc_38:
    s_add_u32 s62, s65, s90
    s_cmp_eq_u32 s65, 0
    s_cselect_b32 s62, 0, s62
    s_cmp_eq_u32 s62, 10
    s_cselect_b32 s62, 1, s62
    s_mul_i32 s59, s75, s62
    s_add_u32 s59, s74, s59
    s_cmp_ge_u32 s59, 10
    s_cselect_b32 s60, 10, 0
    s_sub_u32 s59, s59, s60
    s_lshl_b32 s59, s59, 7
    s_andn2_b32 s60, 7, s65
    s_mul_i32 s60, s60, 20480
    s_add_u32 s60, s60, s73
    s_add_u32 m0, s60, 0
    s_nop 0
    buffer_load_dwordx4 v44, s[44:47], s59 offen lds
    s_add_u32 m0, s60, 1024
    s_nop 0
    buffer_load_dwordx4 v45, s[44:47], s59 offen lds
    s_add_u32 m0, s60, 2048
    s_nop 0
    buffer_load_dwordx4 v46, s[44:47], s59 offen lds
    s_add_u32 m0, s60, 3072
    s_nop 0
    buffer_load_dwordx4 v47, s[44:47], s59 offen lds
    s_add_u32 m0, s60, 4096
    s_nop 0
    buffer_load_dwordx4 v48, s[44:47], s59 offen lds
    s_add_u32 s65, s65, 1
    s_cmp_lt_u32 s65, 6
    s_cbranch_scc1 L_bc_38
    s_waitcnt vmcnt(15)
    s_barrier
    s_barrier
    s_mov_b32 s65, 6
L_bc_39:
    s_add_u32 s62, s65, s90
    s_cmp_eq_u32 s65, 0
    s_cselect_b32 s62, 0, s62
    s_cmp_eq_u32 s62, 10
    s_cselect_b32 s62, 1, s62
    s_mul_i32 s59, s75, s62
    s_add_u32 s59, s74, s59
    s_cmp_ge_u32 s59, 10
    s_cselect_b32 s60, 10, 0
    s_sub_u32 s59, s59, s60
    s_lshl_b32 s59, s59, 7
    s_andn2_b32 s60, 7, s65
    s_mul_i32 s60, s60, 20480
    s_add_u32 s60, s60, s73
    s_add_u32 m0, s60, 0
    s_nop 0
    buffer_load_dwordx4 v44, s[44:47], s59 offen lds
    s_add_u32 m0, s60, 1024
    s_nop 0
    buffer_load_dwordx4 v45, s[44:47], s59 offen lds
    s_add_u32 m0, s60, 2048
    s_nop 0
    buffer_load_dwordx4 v46, s[44:47], s59 offen lds
    s_add_u32 m0, s60, 3072
    s_nop 0
    buffer_load_dwordx4 v47, s[44:47], s59 offen lds
    s_add_u32 m0, s60, 4096
    s_nop 0
    buffer_load_dwordx4 v48, s[44:47], s59 offen lds
    s_add_u32 s65, s65, 1
    s_cmp_lt_u32 s65, 8
    s_cbranch_scc1 L_bc_39
    s_waitcnt vmcnt(10)
    s_barrier
    s_waitcnt vmcnt(0)
    s_barrier
    s_mov_b32 s65, 8
L_bc_40:
    s_add_u32 s62, s65, s90
    s_cmp_eq_u32 s65, 0
    s_cselect_b32 s62, 0, s62
    s_cmp_eq_u32 s62, 10
    s_cselect_b32 s62, 1, s62
    s_mul_i32 s59, s75, s62
    s_add_u32 s59, s74, s59
    s_cmp_ge_u32 s59, 10
    s_cselect_b32 s60, 10, 0
    s_sub_u32 s59, s59, s60
    s_lshl_b32 s59, s59, 7
    s_andn2_b32 s60, 7, s65
    s_mul_i32 s60, s60, 20480
    s_add_u32 s60, s60, s73
    s_add_u32 m0, s60, 0
    s_nop 0
    buffer_load_dwordx4 v44, s[44:47], s59 offen lds
    s_add_u32 m0, s60, 1024
    s_nop 0
    buffer_load_dwordx4 v45, s[44:47], s59 offen lds
    s_add_u32 m0, s60, 2048
    s_nop 0
    buffer_load_dwordx4 v46, s[44:47], s59 offen lds
    s_add_u32 m0, s60, 3072
    s_nop 0
    buffer_load_dwordx4 v47, s[44:47], s59 offen lds
    s_add_u32 m0, s60, 4096
    s_nop 0
    buffer_load_dwordx4 v48, s[44:47], s59 offen lds
    s_add_u32 s65, s65, 1
    s_cmp_lt_u32 s65, 10
    s_cbranch_scc1 L_bc_40
    s_waitcnt vmcnt(0)
    s_barrier
    s_endpgm
L_BC:
    v_and_b32 v250, 15, v0
    v_lshrrev_b32 v251, 4, v0
    v_lshrrev_b32 v252, 1, v250
    v_xor_b32 v252, v252, v251
    s_lshl_b32 s59, s55, 12
    s_add_u32 s59, s59, 16384
    v_lshlrev_b32 v252, 4, v252
    v_lshl_add_u32 v252, v250, 7, v252
    v_add_u32 v1, s59, v252
    v_xor_b32 v2, 64, v1
    v_add_u32 v3, 32768, v252
    v_xor_b32 v4, 64, v3
    s_mul_i32 s59, s53, 160
    v_lshlrev_b32 v252, 1, v250
    v_add_u32 v5, s59, v252
    s_lshl_b32 s59, s53, 7
    v_add_u32 v6, s59, v252
    s_lshl_b32 s59, s53, 5
    s_add_u32 s59, s59, 1024
    v_add_u32 v7, s59, v252
    v_mov_b64 v[88:89], 0
    v_mov_b32 v98, 0
    v_mov_b32 v234, 0
    v_mov_b64 v[90:91], 0
    v_mov_b32 v99, 0
    v_mov_b32 v235, 0
    v_mov_b64 v[92:93], 0
    v_mov_b32 v100, 0
    v_mov_b32 v236, 0
    v_mov_b64 v[94:95], 0
    v_mov_b32 v101, 0
    v_mov_b32 v237, 0
    v_mov_b64 v[96:97], 0
    v_mov_b32 v102, 0
    v_mov_b32 v238, 0
    s_waitcnt lgkmcnt(0)
    s_mov_b32 s36, s24
    s_mov_b32 s37, s25
    s_mov_b32 s38, 1280
    s_mov_b32 s39, 0x20000
    buffer_load_short_d16_hi v98, v6, s[36:39], 0 offen offset:0
    buffer_load_short_d16_hi v99, v6, s[36:39], 0 offen offset:32
    buffer_load_short_d16_hi v100, v6, s[36:39], 0 offen offset:64
    buffer_load_short_d16_hi v101, v6, s[36:39], 0 offen offset:96
    buffer_load_short_d16_hi v102, v7, s[36:39], 0 offen offset:0
    s_mov_b32 s36, s12
    s_mov_b32 s37, s13
    s_mov_b32 s38, 1280
    s_mov_b32 s39, 0x20000
    buffer_load_short_d16_hi v88, v6, s[36:39], 0 offen offset:0
    buffer_load_short_d16_hi v90, v6, s[36:39], 0 offen offset:32
    buffer_load_short_d16_hi v92, v6, s[36:39], 0 offen offset:64
    buffer_load_short_d16_hi v94, v6, s[36:39], 0 offen offset:96
    buffer_load_short_d16_hi v96, v7, s[36:39], 0 offen offset:0
    s_mov_b32 s36, s14
    s_mov_b32 s37, s15
    s_mov_b32 s38, 1280
    s_mov_b32 s39, 0x20000
    buffer_load_short_d16_hi v89, v6, s[36:39], 0 offen offset:0
    buffer_load_short_d16_hi v91, v6, s[36:39], 0 offen offset:32
    buffer_load_short_d16_hi v93, v6, s[36:39], 0 offen offset:64
    buffer_load_short_d16_hi v95, v6, s[36:39], 0 offen offset:96
    buffer_load_short_d16_hi v97, v7, s[36:39], 0 offen offset:0
    s_mov_b32 s36, s26
    s_mov_b32 s37, s27
    s_mov_b32 s38, 1280
    s_mov_b32 s39, 0x20000
    buffer_load_short_d16_hi v234, v5, s[36:39], 0 offen offset:0
    buffer_load_short_d16_hi v235, v5, s[36:39], 0 offen offset:32
    buffer_load_short_d16_hi v236, v5, s[36:39], 0 offen offset:64
    buffer_load_short_d16_hi v237, v5, s[36:39], 0 offen offset:96
    buffer_load_short_d16_hi v238, v5, s[36:39], 0 offen offset:128
    s_lshl_b32 s59, s35, 8
    s_load_dword s56, s[32:33], s59
    s_mov_b32 s48, s32
    s_mov_b32 s49, s33
    s_mov_b32 s50, 268435456
    s_mov_b32 s51, 0x20000
    s_cmp_lg_u32 s55, 0
    s_cbranch_scc1 L_bc_nopf
    s_getpc_b64 s[68:69]
L_pc_41:
    s_sub_u32 s68, s68, L_pc_41-L_BL
    s_subb_u32 s69, s69, 0
    s_lshl_b32 s59, s54, 3
    s_add_u32 s59, s59, s53
    s_lshl_b32 s59, s59, 7
    v_lshlrev_b32 v249, 12, v0
    v_add_u32 v249, s59, v249
    v_cmp_gt_u32 vcc, L_END-L_BL, v249
    s_and_saveexec_b64 s[70:71], vcc
    s_cbranch_execz L_pcs_42
    global_load_dword v255, v249, s[68:69]
L_pcs_42:
    s_mov_b64 exec, -1
L_bc_nopf:
    v_mov_b32 v8, 0
    v_mov_b32 v9, 0
    v_mov_b32 v10, 0
    v_mov_b32 v11, 0
    v_mov_b32 v12, 0
    v_mov_b32 v13, 0
    v_mov_b32 v14, 0
    v_mov_b32 v15, 0
    v_mov_b32 v16, 0
    v_mov_b32 v17, 0
    v_mov_b32 v18, 0
    v_mov_b32 v19, 0
    v_mov_b32 v20, 0
    v_mov_b32 v21, 0
    v_mov_b32 v22, 0
    v_mov_b32 v23, 0
    v_mov_b32 v24, 0
    v_mov_b32 v25, 0
    v_mov_b32 v26, 0
    v_mov_b32 v27, 0
    v_mov_b32 v28, 0
    v_mov_b32 v29, 0
    v_mov_b32 v30, 0
    v_mov_b32 v31, 0
    v_mov_b32 v32, 0
    v_mov_b32 v33, 0
    v_mov_b32 v34, 0
    v_mov_b32 v35, 0
    v_mov_b32 v36, 0
    v_mov_b32 v37, 0
    v_mov_b32 v38, 0
    v_mov_b32 v39, 0
    v_mov_b32 v40, 0
    v_mov_b32 v41, 0
    v_mov_b32 v42, 0
    v_mov_b32 v43, 0
    v_mov_b32 v44, 0
    v_mov_b32 v45, 0
    v_mov_b32 v46, 0
    v_mov_b32 v47, 0
    v_mov_b32 v48, 0
    v_mov_b32 v49, 0
    v_mov_b32 v50, 0
    v_mov_b32 v51, 0
    v_mov_b32 v52, 0
    v_mov_b32 v53, 0
    v_mov_b32 v54, 0
    v_mov_b32 v55, 0
    v_mov_b32 v56, 0
    v_mov_b32 v57, 0
    v_mov_b32 v58, 0
    v_mov_b32 v59, 0
    v_mov_b32 v60, 0
    v_mov_b32 v61, 0
    v_mov_b32 v62, 0
    v_mov_b32 v63, 0
    v_mov_b32 v64, 0
    v_mov_b32 v65, 0
    v_mov_b32 v66, 0
    v_mov_b32 v67, 0
    v_mov_b32 v68, 0
    v_mov_b32 v69, 0
    v_mov_b32 v70, 0
    v_mov_b32 v71, 0
    v_mov_b32 v72, 0
    v_mov_b32 v73, 0
    v_mov_b32 v74, 0
    v_mov_b32 v75, 0
    v_mov_b32 v76, 0
    v_mov_b32 v77, 0
    v_mov_b32 v78, 0
    v_mov_b32 v79, 0
    v_mov_b32 v80, 0
    v_mov_b32 v81, 0
    v_mov_b32 v82, 0
    v_mov_b32 v83, 0
    v_mov_b32 v84, 0
    v_mov_b32 v85, 0
    v_mov_b32 v86, 0
    v_mov_b32 v87, 0
    s_mul_i32 s59, s55, 768
    v_mul_u32_u24 v5, 48, v250
    v_and_b32 v253, 1, v251
    v_lshlrev_b32 v253, 3, v253
    v_lshrrev_b32 v254, 1, v251
    v_lshl_add_u32 v253, v254, 2, v253
    v_add3_u32 v6, v5, v253, s59
    v_lshlrev_b32 v7, 4, v0
    s_mul_i32 s59, s55, 2560
    v_mul_u32_u24 v252, 640, v251
    v_lshlrev_b32 v224, 3, v250
    v_add3_u32 v239, v252, v224, s59
    v_lshrrev_b32 v252, 2, v0
    v_mul_u32_u24 v252, 160, v252
    v_and_b32 v253, 3, v0
    v_lshl_add_u32 v252, v253, 3, v252
    s_mul_i32 s59, s55, 5120
    s_add_u32 s59, s59, 20480
    v_add_u32 v249, s59, v252
    v_mul_u32_u24 v252, 768, v251
    v_lshl_add_u32 v226, v250, 4, v252
    s_lshl_b32 s90, s53, 4
    s_lshl_b32 s60, s55, 2
    s_add_u32 s90, s90, s60
    s_mul_i32 s90, s90, 768
    s_add_u32 s90, s90, 65536
    s_lshl_b32 s92, s52, 2
    s_add_u32 s92, s92, s55
    s_mul_i32 s92, s92, 81920
    s_add_u32 s92, s92, 4194304
    s_lshl_b32 s91, s53, 13
    s_add_u32 s91, s91, s92
    s_lshl_b32 s93, s53, 11
    s_add_u32 s93, s93, s92
    s_add_u32 s93, s93, 65536
    v_lshlrev_b32 v251, 3, v251
    v_sub_u32 v252, v250, v251
    v_mov_b32 v253, 0x3f80
    v_mov_b32 v254, 0x3f800000
    v_cmp_eq_u32 vcc, 0, v252
    s_nop 1
    v_cndmask_b32 v240, 0, v253, vcc
    v_cmp_eq_u32 vcc, 4, v252
    s_nop 1
    v_cndmask_b32 v240, v240, v254, vcc
    v_cmp_eq_u32 vcc, 1, v252
    s_nop 1
    v_cndmask_b32 v241, 0, v253, vcc
    v_cmp_eq_u32 vcc, 5, v252
    s_nop 1
    v_cndmask_b32 v241, v241, v254, vcc
    v_cmp_eq_u32 vcc, 2, v252
    s_nop 1
    v_cndmask_b32 v242, 0, v253, vcc
    v_cmp_eq_u32 vcc, 6, v252
    s_nop 1
    v_cndmask_b32 v242, v242, v254, vcc
    v_cmp_eq_u32 vcc, 3, v252
    s_nop 1
    v_cndmask_b32 v243, 0, v253, vcc
    v_cmp_eq_u32 vcc, 7, v252
    s_nop 1
    v_cndmask_b32 v243, v243, v254, vcc
    v_cmp_eq_u32 vcc, -16, v252
    s_nop 1
    v_cndmask_b32 v244, 0, v253, vcc
    v_cmp_eq_u32 vcc, -12, v252
    s_nop 1
    v_cndmask_b32 v244, v244, v254, vcc
    v_cmp_eq_u32 vcc, -15, v252
    s_nop 1
    v_cndmask_b32 v245, 0, v253, vcc
    v_cmp_eq_u32 vcc, -11, v252
    s_nop 1
    v_cndmask_b32 v245, v245, v254, vcc
    v_cmp_eq_u32 vcc, -14, v252
    s_nop 1
    v_cndmask_b32 v246, 0, v253, vcc
    v_cmp_eq_u32 vcc, -10, v252
    s_nop 1
    v_cndmask_b32 v246, v246, v254, vcc
    v_cmp_eq_u32 vcc, -13, v252
    s_nop 1
    v_cndmask_b32 v247, 0, v253, vcc
    v_cmp_eq_u32 vcc, -9, v252
    s_nop 1
    v_cndmask_b32 v247, v247, v254, vcc
    s_lshl_b32 s59, s55, 2
    v_lshrrev_b32 v251, 4, v0
    v_add_u32 v251, s59, v251
    v_cvt_f32_u32 v252, v251
    v_mul_f32 v105, 0x41000000, v252
    v_sub_f32 v104, 0x42f00000, v105
    s_sub_u32 s59, s52, 1
    v_sub_u32 v253, s59, v251
    v_max_i32 v253, 0, v253
    v_cvt_f32_i32 v253, v253
    v_mul_f32 v106, 0x43000000, v253
    v_cmp_gt_u32 s[74:75], s52, v251
    v_mov_b32 v108, 0x3fb8aa3b
    v_mov_b32 v109, 0.15915494
    s_waitcnt vmcnt(0)
    v_mul_f32 v98, v108, v98
    v_mul_f32 v99, v108, v99
    v_mul_f32 v100, v108, v100
    v_mul_f32 v101, v108, v101
    v_mul_f32 v102, v108, v102
    v_exp_f32 v98, v98
    v_exp_f32 v99, v99
    v_exp_f32 v100, v100
    v_exp_f32 v101, v101
    v_exp_f32 v102, v102
    v_pk_mul_f32 v[110:111], v[88:89], v[108:109]
    v_pk_mul_f32 v[116:117], v[90:91], v[108:109]
    v_pk_mul_f32 v[122:123], v[92:93], v[108:109]
    v_pk_mul_f32 v[128:129], v[94:95], v[108:109]
    v_pk_mul_f32 v[134:135], v[96:97], v[108:109]
    v_cvt_pk_bf16_f32 v98, v98, v98
    v_cvt_pk_bf16_f32 v99, v99, v99
    v_cvt_pk_bf16_f32 v100, v100, v100
    v_cvt_pk_bf16_f32 v101, v101, v101
    v_cvt_pk_bf16_f32 v102, v102, v102
    v_lshlrev_b32 v98, 16, v98
    v_lshlrev_b32 v99, 16, v99
    v_lshlrev_b32 v100, 16, v100
    v_lshlrev_b32 v101, 16, v101
    v_lshlrev_b32 v102, 16, v102
    v_pk_mul_f32 v[110:111], v[110:111], v[98:99] op_sel:[0,0] op_sel_hi:[1,0]
    v_pk_mul_f32 v[116:117], v[116:117], v[98:99] op_sel:[0,1] op_sel_hi:[1,1]
    v_pk_mul_f32 v[122:123], v[122:123], v[100:101] op_sel:[0,0] op_sel_hi:[1,0]
    v_pk_mul_f32 v[128:129], v[128:129], v[100:101] op_sel:[0,1] op_sel_hi:[1,1]
    v_pk_mul_f32 v[134:135], v[134:135], v[102:103] op_sel:[0,0] op_sel_hi:[1,0]
    v_exp_f32 v112, v110
    v_exp_f32 v118, v116
    v_exp_f32 v124, v122
    v_exp_f32 v130, v128
    v_exp_f32 v136, v134
    v_fract_f32 v113, v111
    v_fract_f32 v119, v117
    v_fract_f32 v125, v123
    v_fract_f32 v131, v129
    v_fract_f32 v137, v135
    v_cos_f32 v114, v113
    v_cos_f32 v120, v119
    v_cos_f32 v126, v125
    v_cos_f32 v132, v131
    v_cos_f32 v138, v137
    v_sin_f32 v115, v113
    v_sin_f32 v121, v119
    v_sin_f32 v127, v125
    v_sin_f32 v133, v131
    v_sin_f32 v139, v137
    v_pk_mul_f32 v[144:145], v[114:115], v[112:113] op_sel:[0,0] op_sel_hi:[1,0]
    v_pk_mul_f32 v[146:147], v[120:121], v[118:119] op_sel:[0,0] op_sel_hi:[1,0]
    v_pk_mul_f32 v[148:149], v[126:127], v[124:125] op_sel:[0,0] op_sel_hi:[1,0]
    v_pk_mul_f32 v[150:151], v[132:133], v[130:131] op_sel:[0,0] op_sel_hi:[1,0]
    v_pk_mul_f32 v[152:153], v[138:139], v[136:137] op_sel:[0,0] op_sel_hi:[1,0]
    v_pk_mul_f32 v[112:113], v[144:145], v[144:145] op_sel:[0,0] op_sel_hi:[0,1]
    v_pk_mul_f32 v[118:119], v[146:147], v[146:147] op_sel:[0,0] op_sel_hi:[0,1]
    v_pk_mul_f32 v[124:125], v[148:149], v[148:149] op_sel:[0,0] op_sel_hi:[0,1]
    v_pk_mul_f32 v[130:131], v[150:151], v[150:151] op_sel:[0,0] op_sel_hi:[0,1]
    v_pk_mul_f32 v[136:137], v[152:153], v[152:153] op_sel:[0,0] op_sel_hi:[0,1]
    v_pk_fma_f32 v[112:113], v[144:145], v[144:145], v[112:113] op_sel:[1,1,0] op_sel_hi:[1,0,1] neg_lo:[1,0,0]
    v_pk_fma_f32 v[118:119], v[146:147], v[146:147], v[118:119] op_sel:[1,1,0] op_sel_hi:[1,0,1] neg_lo:[1,0,0]
    v_pk_fma_f32 v[124:125], v[148:149], v[148:149], v[124:125] op_sel:[1,1,0] op_sel_hi:[1,0,1] neg_lo:[1,0,0]
    v_pk_fma_f32 v[130:131], v[150:151], v[150:151], v[130:131] op_sel:[1,1,0] op_sel_hi:[1,0,1] neg_lo:[1,0,0]
    v_pk_fma_f32 v[136:137], v[152:153], v[152:153], v[136:137] op_sel:[1,1,0] op_sel_hi:[1,0,1] neg_lo:[1,0,0]
    v_pk_mul_f32 v[194:195], v[112:113], v[112:113] op_sel:[0,0] op_sel_hi:[0,1]
    v_pk_mul_f32 v[196:197], v[118:119], v[118:119] op_sel:[0,0] op_sel_hi:[0,1]
    v_pk_mul_f32 v[198:199], v[124:125], v[124:125] op_sel:[0,0] op_sel_hi:[0,1]
    v_pk_mul_f32 v[200:201], v[130:131], v[130:131] op_sel:[0,0] op_sel_hi:[0,1]
    v_pk_mul_f32 v[202:203], v[136:137], v[136:137] op_sel:[0,0] op_sel_hi:[0,1]
    v_pk_fma_f32 v[194:195], v[112:113], v[112:113], v[194:195] op_sel:[1,1,0] op_sel_hi:[1,0,1] neg_lo:[1,0,0]
    v_pk_fma_f32 v[196:197], v[118:119], v[118:119], v[196:197] op_sel:[1,1,0] op_sel_hi:[1,0,1] neg_lo:[1,0,0]
    v_pk_fma_f32 v[198:199], v[124:125], v[124:125], v[198:199] op_sel:[1,1,0] op_sel_hi:[1,0,1] neg_lo:[1,0,0]
    v_pk_fma_f32 v[200:201], v[130:131], v[130:131], v[200:201] op_sel:[1,1,0] op_sel_hi:[1,0,1] neg_lo:[1,0,0]
    v_pk_fma_f32 v[202:203], v[136:137], v[136:137], v[202:203] op_sel:[1,1,0] op_sel_hi:[1,0,1] neg_lo:[1,0,0]
    v_pk_mul_f32 v[204:205], v[194:195], v[194:195] op_sel:[0,0] op_sel_hi:[0,1]
    v_pk_mul_f32 v[206:207], v[196:197], v[196:197] op_sel:[0,0] op_sel_hi:[0,1]
    v_pk_mul_f32 v[208:209], v[198:199], v[198:199] op_sel:[0,0] op_sel_hi:[0,1]
    v_pk_mul_f32 v[210:211], v[200:201], v[200:201] op_sel:[0,0] op_sel_hi:[0,1]
    v_pk_mul_f32 v[212:213], v[202:203], v[202:203] op_sel:[0,0] op_sel_hi:[0,1]
    v_pk_fma_f32 v[204:205], v[194:195], v[194:195], v[204:205] op_sel:[1,1,0] op_sel_hi:[1,0,1] neg_lo:[1,0,0]
    v_pk_fma_f32 v[206:207], v[196:197], v[196:197], v[206:207] op_sel:[1,1,0] op_sel_hi:[1,0,1] neg_lo:[1,0,0]
    v_pk_fma_f32 v[208:209], v[198:199], v[198:199], v[208:209] op_sel:[1,1,0] op_sel_hi:[1,0,1] neg_lo:[1,0,0]
    v_pk_fma_f32 v[210:211], v[200:201], v[200:201], v[210:211] op_sel:[1,1,0] op_sel_hi:[1,0,1] neg_lo:[1,0,0]
    v_pk_fma_f32 v[212:213], v[202:203], v[202:203], v[212:213] op_sel:[1,1,0] op_sel_hi:[1,0,1] neg_lo:[1,0,0]
    v_pk_mul_f32 v[112:113], v[110:111], v[104:105] op_sel:[0,0] op_sel_hi:[1,0]
    v_pk_mul_f32 v[118:119], v[116:117], v[104:105] op_sel:[0,0] op_sel_hi:[1,0]
    v_pk_mul_f32 v[124:125], v[122:123], v[104:105] op_sel:[0,0] op_sel_hi:[1,0]
    v_pk_mul_f32 v[130:131], v[128:129], v[104:105] op_sel:[0,0] op_sel_hi:[1,0]
    v_pk_mul_f32 v[136:137], v[134:135], v[104:105] op_sel:[0,0] op_sel_hi:[1,0]
    v_exp_f32 v112, v112
    v_exp_f32 v118, v118
    v_exp_f32 v124, v124
    v_exp_f32 v130, v130
    v_exp_f32 v136, v136
    v_fract_f32 v113, v113
    v_fract_f32 v119, v119
    v_fract_f32 v125, v125
    v_fract_f32 v131, v131
    v_fract_f32 v137, v137
    v_cos_f32 v114, v113
    v_cos_f32 v120, v119
    v_cos_f32 v126, v125
    v_cos_f32 v132, v131
    v_cos_f32 v138, v137
    v_sin_f32 v115, v113
    v_sin_f32 v121, v119
    v_sin_f32 v127, v125
    v_sin_f32 v133, v131
    v_sin_f32 v139, v137
    v_pk_mul_f32 v[214:215], v[114:115], v[112:113] op_sel:[0,0] op_sel_hi:[1,0]
    v_pk_mul_f32 v[216:217], v[120:121], v[118:119] op_sel:[0,0] op_sel_hi:[1,0]
    v_pk_mul_f32 v[218:219], v[126:127], v[124:125] op_sel:[0,0] op_sel_hi:[1,0]
    v_pk_mul_f32 v[220:221], v[132:133], v[130:131] op_sel:[0,0] op_sel_hi:[1,0]
    v_pk_mul_f32 v[222:223], v[138:139], v[136:137] op_sel:[0,0] op_sel_hi:[1,0]
    v_pk_mul_f32 v[112:113], v[110:111], v[106:107] op_sel:[0,0] op_sel_hi:[1,0]
    v_pk_mul_f32 v[118:119], v[116:117], v[106:107] op_sel:[0,0] op_sel_hi:[1,0]
    v_pk_mul_f32 v[124:125], v[122:123], v[106:107] op_sel:[0,0] op_sel_hi:[1,0]
    v_pk_mul_f32 v[130:131], v[128:129], v[106:107] op_sel:[0,0] op_sel_hi:[1,0]
    v_pk_mul_f32 v[136:137], v[134:135], v[106:107] op_sel:[0,0] op_sel_hi:[1,0]
    v_exp_f32 v112, v112
    v_exp_f32 v118, v118
    v_exp_f32 v124, v124
    v_exp_f32 v130, v130
    v_exp_f32 v136, v136
    v_fract_f32 v113, v113
    v_fract_f32 v119, v119
    v_fract_f32 v125, v125
    v_fract_f32 v131, v131
    v_fract_f32 v137, v137
    v_cos_f32 v114, v113
    v_cos_f32 v120, v119
    v_cos_f32 v126, v125
    v_cos_f32 v132, v131
    v_cos_f32 v138, v137
    v_sin_f32 v115, v113
    v_sin_f32 v121, v119
    v_sin_f32 v127, v125
    v_sin_f32 v133, v131
    v_sin_f32 v139, v137
    v_pk_mul_f32 v[184:185], v[114:115], v[112:113] op_sel:[0,0] op_sel_hi:[1,0]
    v_pk_mul_f32 v[186:187], v[120:121], v[118:119] op_sel:[0,0] op_sel_hi:[1,0]
    v_pk_mul_f32 v[188:189], v[126:127], v[124:125] op_sel:[0,0] op_sel_hi:[1,0]
    v_pk_mul_f32 v[190:191], v[132:133], v[130:131] op_sel:[0,0] op_sel_hi:[1,0]
    v_pk_mul_f32 v[192:193], v[138:139], v[136:137] op_sel:[0,0] op_sel_hi:[1,0]
    v_pk_mul_f32 v[112:113], v[88:89], v[88:89]
    v_pk_mul_f32 v[118:119], v[90:91], v[90:91]
    v_pk_mul_f32 v[124:125], v[92:93], v[92:93]
    v_pk_mul_f32 v[130:131], v[94:95], v[94:95]
    v_pk_mul_f32 v[136:137], v[96:97], v[96:97]
    v_add_f32 v114, -1.0, v144
    v_add_f32 v120, -1.0, v146
    v_add_f32 v126, -1.0, v148
    v_add_f32 v132, -1.0, v150
    v_add_f32 v138, -1.0, v152
    v_add_f32 v112, v112, v113
    v_add_f32 v118, v118, v119
    v_add_f32 v124, v124, v125
    v_add_f32 v130, v130, v131
    v_add_f32 v136, v136, v137
    v_mov_b32 v115, v145
    v_mov_b32 v121, v147
    v_mov_b32 v127, v149
    v_mov_b32 v133, v151
    v_mov_b32 v139, v153
    v_rcp_f32 v112, v112
    v_rcp_f32 v118, v118
    v_rcp_f32 v124, v124
    v_rcp_f32 v130, v130
    v_rcp_f32 v136, v136
    v_pk_mul_f32 v[154:155], v[88:89], v[114:115] op_sel:[0,0] op_sel_hi:[0,1]
    v_pk_mul_f32 v[156:157], v[90:91], v[120:121] op_sel:[0,0] op_sel_hi:[0,1]
    v_pk_mul_f32 v[158:159], v[92:93], v[126:127] op_sel:[0,0] op_sel_hi:[0,1]
    v_pk_mul_f32 v[160:161], v[94:95], v[132:133] op_sel:[0,0] op_sel_hi:[0,1]
    v_pk_mul_f32 v[162:163], v[96:97], v[138:139] op_sel:[0,0] op_sel_hi:[0,1]
    v_pk_fma_f32 v[154:155], v[88:89], v[114:115], v[154:155] op_sel:[1,1,0] op_sel_hi:[1,0,1] neg_hi:[1,0,0]
    v_pk_fma_f32 v[156:157], v[90:91], v[120:121], v[156:157] op_sel:[1,1,0] op_sel_hi:[1,0,1] neg_hi:[1,0,0]
    v_pk_fma_f32 v[158:159], v[92:93], v[126:127], v[158:159] op_sel:[1,1,0] op_sel_hi:[1,0,1] neg_hi:[1,0,0]
    v_pk_fma_f32 v[160:161], v[94:95], v[132:133], v[160:161] op_sel:[1,1,0] op_sel_hi:[1,0,1] neg_hi:[1,0,0]
    v_pk_fma_f32 v[162:163], v[96:97], v[138:139], v[162:163] op_sel:[1,1,0] op_sel_hi:[1,0,1] neg_hi:[1,0,0]
    v_add_f32 v112, v112, v112
    v_add_f32 v118, v118, v118
    v_add_f32 v124, v124, v124
    v_add_f32 v130, v130, v130
    v_add_f32 v136, v136, v136
    v_pk_mul_f32 v[154:155], v[154:155], v[112:113] op_sel:[0,0] op_sel_hi:[1,0]
    v_pk_mul_f32 v[156:157], v[156:157], v[118:119] op_sel:[0,0] op_sel_hi:[1,0]
    v_pk_mul_f32 v[158:159], v[158:159], v[124:125] op_sel:[0,0] op_sel_hi:[1,0]
    v_pk_mul_f32 v[160:161], v[160:161], v[130:131] op_sel:[0,0] op_sel_hi:[1,0]
    v_pk_mul_f32 v[162:163], v[162:163], v[136:137] op_sel:[0,0] op_sel_hi:[1,0]
    v_pk_mul_f32 v[112:113], v[110:111], v[104:105] op_sel:[0,1] op_sel_hi:[1,1]
    v_pk_mul_f32 v[118:119], v[116:117], v[104:105] op_sel:[0,1] op_sel_hi:[1,1]
    v_pk_mul_f32 v[124:125], v[122:123], v[104:105] op_sel:[0,1] op_sel_hi:[1,1]
    v_pk_mul_f32 v[130:131], v[128:129], v[104:105] op_sel:[0,1] op_sel_hi:[1,1]
    v_pk_mul_f32 v[136:137], v[134:135], v[104:105] op_sel:[0,1] op_sel_hi:[1,1]
    v_exp_f32 v112, v112
    v_exp_f32 v118, v118
    v_exp_f32 v124, v124
    v_exp_f32 v130, v130
    v_exp_f32 v136, v136
    v_fract_f32 v113, v113
    v_fract_f32 v119, v119
    v_fract_f32 v125, v125
    v_fract_f32 v131, v131
    v_fract_f32 v137, v137
    v_cos_f32 v114, v113
    v_cos_f32 v120, v119
    v_cos_f32 v126, v125
    v_cos_f32 v132, v131
    v_cos_f32 v138, v137
    v_sin_f32 v115, v113
    v_sin_f32 v121, v119
    v_sin_f32 v127, v125
    v_sin_f32 v133, v131
    v_sin_f32 v139, v137
    v_pk_mul_f32 v[110:111], v[114:115], v[112:113] op_sel:[0,0] op_sel_hi:[1,0]
    v_pk_mul_f32 v[116:117], v[120:121], v[118:119] op_sel:[0,0] op_sel_hi:[1,0]
    v_pk_mul_f32 v[122:123], v[126:127], v[124:125] op_sel:[0,0] op_sel_hi:[1,0]
    v_pk_mul_f32 v[128:129], v[132:133], v[130:131] op_sel:[0,0] op_sel_hi:[1,0]
    v_pk_mul_f32 v[134:135], v[138:139], v[136:137] op_sel:[0,0] op_sel_hi:[1,0]
    v_pk_mul_f32 v[112:113], v[154:155], v[110:111] op_sel:[0,0] op_sel_hi:[0,1]
    v_pk_mul_f32 v[118:119], v[156:157], v[116:117] op_sel:[0,0] op_sel_hi:[0,1]
    v_pk_mul_f32 v[124:125], v[158:159], v[122:123] op_sel:[0,0] op_sel_hi:[0,1]
    v_pk_mul_f32 v[130:131], v[160:161], v[128:129] op_sel:[0,0] op_sel_hi:[0,1]
    v_pk_mul_f32 v[136:137], v[162:163], v[134:135] op_sel:[0,0] op_sel_hi:[0,1]
    v_pk_fma_f32 v[112:113], v[154:155], v[110:111], v[112:113] op_sel:[1,1,0] op_sel_hi:[1,0,1] neg_lo:[1,0,0]
    v_pk_fma_f32 v[118:119], v[156:157], v[116:117], v[118:119] op_sel:[1,1,0] op_sel_hi:[1,0,1] neg_lo:[1,0,0]
    v_pk_fma_f32 v[124:125], v[158:159], v[122:123], v[124:125] op_sel:[1,1,0] op_sel_hi:[1,0,1] neg_lo:[1,0,0]
    v_pk_fma_f32 v[130:131], v[160:161], v[128:129], v[130:131] op_sel:[1,1,0] op_sel_hi:[1,0,1] neg_lo:[1,0,0]
    v_pk_fma_f32 v[136:137], v[162:163], v[134:135], v[136:137] op_sel:[1,1,0] op_sel_hi:[1,0,1] neg_lo:[1,0,0]
    v_pk_mul_f32 v[114:115], v[194:195], v[112:113] op_sel:[0,0] op_sel_hi:[0,1]
    v_pk_mul_f32 v[120:121], v[196:197], v[118:119] op_sel:[0,0] op_sel_hi:[0,1]
    v_pk_mul_f32 v[126:127], v[198:199], v[124:125] op_sel:[0,0] op_sel_hi:[0,1]
    v_pk_mul_f32 v[132:133], v[200:201], v[130:131] op_sel:[0,0] op_sel_hi:[0,1]
    v_pk_mul_f32 v[138:139], v[202:203], v[136:137] op_sel:[0,0] op_sel_hi:[0,1]
    v_pk_fma_f32 v[114:115], v[194:195], v[112:113], v[114:115] op_sel:[1,1,0] op_sel_hi:[1,0,1] neg_lo:[1,0,0]
    v_pk_fma_f32 v[120:121], v[196:197], v[118:119], v[120:121] op_sel:[1,1,0] op_sel_hi:[1,0,1] neg_lo:[1,0,0]
    v_pk_fma_f32 v[126:127], v[198:199], v[124:125], v[126:127] op_sel:[1,1,0] op_sel_hi:[1,0,1] neg_lo:[1,0,0]
    v_pk_fma_f32 v[132:133], v[200:201], v[130:131], v[132:133] op_sel:[1,1,0] op_sel_hi:[1,0,1] neg_lo:[1,0,0]
    v_pk_fma_f32 v[138:139], v[202:203], v[136:137], v[138:139] op_sel:[1,1,0] op_sel_hi:[1,0,1] neg_lo:[1,0,0]
    v_pk_mov_b32 v[164:165], v[112:113], v[114:115] op_sel:[0,0]
    v_pk_mov_b32 v[168:169], v[118:119], v[120:121] op_sel:[0,0]
    v_pk_mov_b32 v[172:173], v[124:125], v[126:127] op_sel:[0,0]
    v_pk_mov_b32 v[176:177], v[130:131], v[132:133] op_sel:[0,0]
    v_pk_mov_b32 v[180:181], v[136:137], v[138:139] op_sel:[0,0]
    v_pk_mov_b32 v[166:167], v[112:113], v[114:115] op_sel:[1,1]
    v_pk_mov_b32 v[170:171], v[118:119], v[120:121] op_sel:[1,1]
    v_pk_mov_b32 v[174:175], v[124:125], v[126:127] op_sel:[1,1]
    v_pk_mov_b32 v[178:179], v[130:131], v[132:133] op_sel:[1,1]
    v_pk_mov_b32 v[182:183], v[136:137], v[138:139] op_sel:[1,1]
    s_waitcnt lgkmcnt(0)
    s_mul_i32 s56, s56, 1664525
    s_add_u32 s56, s56, 1013904223
    s_max_u32 s56, s56, 16
    s_mov_b32 s58, 0
    s_mov_b32 s65, 0
    s_mov_b32 s60, 36864
    s_barrier
    ds_read_b128 v[88:91], v1 offset:0
    ds_read_b128 v[92:95], v1 offset:2048
    ds_read_b128 v[104:107], v3 offset:0
    ds_read_b128 v[108:111], v3 offset:2048
    ds_read_b128 v[112:115], v3 offset:4096
    ds_read_b128 v[116:119], v3 offset:6144
    ds_read_b128 v[120:123], v3 offset:8192
    .p2align 3
L_main_44:
    s_waitcnt lgkmcnt(4)
    v_mfma_f32_16x16x32_bf16 v[8:11], v[88:91], v[104:107], v[8:11]
    v_mfma_f32_16x16x32_bf16 v[12:15], v[92:95], v[104:107], v[12:15]
    ds_read_b128 v[124:127], v3 offset:10240
    s_waitcnt lgkmcnt(4)
    v_mfma_f32_16x16x32_bf16 v[16:19], v[88:91], v[108:111], v[16:19]
    ds_read_b128 v[128:131], v3 offset:12288
    s_waitcnt lgkmcnt(4)
    v_mfma_f32_16x16x32_bf16 v[20:23], v[92:95], v[108:111], v[20:23]
    ds_read_b128 v[132:135], v3 offset:14336
    s_add_u32 s58, s58, 1
    v_mfma_f32_16x16x32_bf16 v[24:27], v[88:91], v[112:115], v[24:27]
    s_cmp_eq_u32 s58, 4
    s_cselect_b32 s59, 0xfffe5000, s60
    v_mfma_f32_16x16x32_bf16 v[28:31], v[92:95], v[112:115], v[28:31]
    s_cselect_b32 s58, 0, s58
    s_waitcnt lgkmcnt(4)
    v_mfma_f32_16x16x32_bf16 v[32:35], v[88:91], v[116:119], v[32:35]
    v_mfma_f32_16x16x32_bf16 v[36:39], v[92:95], v[116:119], v[36:39]
    ds_read_b128 v[136:139], v3 offset:16384
    s_waitcnt lgkmcnt(4)
    v_mfma_f32_16x16x32_bf16 v[40:43], v[88:91], v[120:123], v[40:43]
    v_mfma_f32_16x16x32_bf16 v[44:47], v[92:95], v[120:123], v[44:47]
    ds_read_b128 v[140:143], v3 offset:18432
    s_waitcnt lgkmcnt(4)
    v_mfma_f32_16x16x32_bf16 v[48:51], v[88:91], v[124:127], v[48:51]
    ds_read_b128 v[96:99], v2 offset:0
    ds_read_b128 v[100:103], v2 offset:2048
    v_mfma_f32_16x16x32_bf16 v[52:55], v[92:95], v[124:127], v[52:55]
    ds_read_b128 v[104:107], v4 offset:0
    s_waitcnt lgkmcnt(6)
    v_mfma_f32_16x16x32_bf16 v[56:59], v[88:91], v[128:131], v[56:59]
    v_mfma_f32_16x16x32_bf16 v[60:63], v[92:95], v[128:131], v[60:63]
    ds_read_b128 v[108:111], v4 offset:2048
    s_waitcnt lgkmcnt(6)
    v_mfma_f32_16x16x32_bf16 v[64:67], v[88:91], v[132:135], v[64:67]
    v_mfma_f32_16x16x32_bf16 v[68:71], v[92:95], v[132:135], v[68:71]
    ds_read_b128 v[112:115], v4 offset:4096
    s_waitcnt lgkmcnt(6)
    v_mfma_f32_16x16x32_bf16 v[72:75], v[88:91], v[136:139], v[72:75]
    v_mfma_f32_16x16x32_bf16 v[76:79], v[92:95], v[136:139], v[76:79]
    ds_read_b128 v[116:119], v4 offset:6144
    s_waitcnt lgkmcnt(6)
    v_mfma_f32_16x16x32_bf16 v[80:83], v[88:91], v[140:143], v[80:83]
    v_mfma_f32_16x16x32_bf16 v[84:87], v[92:95], v[140:143], v[84:87]
    ds_read_b128 v[120:123], v4 offset:8192
    s_waitcnt lgkmcnt(4)
    v_mfma_f32_16x16x32_bf16 v[8:11], v[96:99], v[104:107], v[8:11]
    v_mfma_f32_16x16x32_bf16 v[12:15], v[100:103], v[104:107], v[12:15]
    ds_read_b128 v[124:127], v4 offset:10240
    s_waitcnt lgkmcnt(4)
    v_mfma_f32_16x16x32_bf16 v[16:19], v[96:99], v[108:111], v[16:19]
    ds_read_b128 v[128:131], v4 offset:12288
    v_mfma_f32_16x16x32_bf16 v[20:23], v[100:103], v[108:111], v[20:23]
    s_waitcnt lgkmcnt(4)
    ds_read_b128 v[132:135], v4 offset:14336
    v_mfma_f32_16x16x32_bf16 v[24:27], v[96:99], v[112:115], v[24:27]
    s_waitcnt lgkmcnt(4)
    ds_read_b128 v[136:139], v4 offset:16384
    v_mfma_f32_16x16x32_bf16 v[28:31], v[100:103], v[112:115], v[28:31]
    s_waitcnt lgkmcnt(4)
    ds_read_b128 v[140:143], v4 offset:18432
    v_mfma_f32_16x16x32_bf16 v[32:35], v[96:99], v[116:119], v[32:35]
    v_add_u32 v1, s59, v1
    v_add_u32 v2, s59, v2
    v_mfma_f32_16x16x32_bf16 v[36:39], v[100:103], v[116:119], v[36:39]
    v_add_u32 v3, s59, v3
    v_add_u32 v4, s59, v4
    v_mfma_f32_16x16x32_bf16 v[40:43], v[96:99], v[120:123], v[40:43]
    s_cmp_eq_u32 s65, 9
    s_cbranch_scc1 L_nb_43
    s_barrier
L_nb_43:
    v_mfma_f32_16x16x32_bf16 v[44:47], v[100:103], v[120:123], v[44:47]
    s_waitcnt lgkmcnt(4)
    v_mfma_f32_16x16x32_bf16 v[48:51], v[96:99], v[124:127], v[48:51]
    ds_read_b128 v[88:91], v1 offset:0
    ds_read_b128 v[92:95], v1 offset:2048
    v_mfma_f32_16x16x32_bf16 v[52:55], v[100:103], v[124:127], v[52:55]
    ds_read_b128 v[104:107], v3 offset:0
    s_waitcnt lgkmcnt(6)
    v_mfma_f32_16x16x32_bf16 v[56:59], v[96:99], v[128:131], v[56:59]
    v_mfma_f32_16x16x32_bf16 v[60:63], v[100:103], v[128:131], v[60:63]
    ds_read_b128 v[108:111], v3 offset:2048
    s_waitcnt lgkmcnt(6)
    v_mfma_f32_16x16x32_bf16 v[64:67], v[96:99], v[132:135], v[64:67]
    ds_read_b128 v[112:115], v3 offset:4096
    s_add_u32 s65, s65, 1
    v_mfma_f32_16x16x32_bf16 v[68:71], v[100:103], v[132:135], v[68:71]
    s_cmp_lt_u32 s65, 10
    s_waitcnt lgkmcnt(6)
    v_mfma_f32_16x16x32_bf16 v[72:75], v[96:99], v[136:139], v[72:75]
    v_mfma_f32_16x16x32_bf16 v[76:79], v[100:103], v[136:139], v[76:79]
    ds_read_b128 v[116:119], v3 offset:6144
    s_waitcnt lgkmcnt(6)
    v_mfma_f32_16x16x32_bf16 v[80:83], v[96:99], v[140:143], v[80:83]
    ds_read_b128 v[120:123], v3 offset:8192
    v_mfma_f32_16x16x32_bf16 v[84:87], v[100:103], v[140:143], v[84:87]
    s_cbranch_scc1 L_main_44
    s_waitcnt lgkmcnt(0)
    v_pk_fma_f32 v[108:109], v[144:145], v[48:49], v[10:11] op_sel:[1,0,0] op_sel_hi:[1,1,1] neg_lo:[1,0,0] neg_hi:[1,0,0]
    v_pk_fma_f32 v[112:113], v[146:147], v[56:57], v[18:19] op_sel:[1,0,0] op_sel_hi:[1,1,1] neg_lo:[1,0,0] neg_hi:[1,0,0]
    v_pk_fma_f32 v[116:117], v[148:149], v[64:65], v[26:27] op_sel:[1,0,0] op_sel_hi:[1,1,1] neg_lo:[1,0,0] neg_hi:[1,0,0]
    v_pk_fma_f32 v[120:121], v[150:151], v[72:73], v[34:35] op_sel:[1,0,0] op_sel_hi:[1,1,1] neg_lo:[1,0,0] neg_hi:[1,0,0]
    v_pk_fma_f32 v[124:125], v[152:153], v[80:81], v[42:43] op_sel:[1,0,0] op_sel_hi:[1,1,1] neg_lo:[1,0,0] neg_hi:[1,0,0]
    v_pk_fma_f32 v[110:111], v[144:145], v[8:9], v[50:51] op_sel:[1,0,0] op_sel_hi:[1,1,1]
    v_pk_fma_f32 v[114:115], v[146:147], v[16:17], v[58:59] op_sel:[1,0,0] op_sel_hi:[1,1,1]
    v_pk_fma_f32 v[118:119], v[148:149], v[24:25], v[66:67] op_sel:[1,0,0] op_sel_hi:[1,1,1]
    v_pk_fma_f32 v[122:123], v[150:151], v[32:33], v[74:75] op_sel:[1,0,0] op_sel_hi:[1,1,1]
    v_pk_fma_f32 v[126:127], v[152:153], v[40:41], v[82:83] op_sel:[1,0,0] op_sel_hi:[1,1,1]
    v_pk_fma_f32 v[88:89], v[144:145], v[8:9], v[108:109] op_sel:[0,0,0] op_sel_hi:[0,1,1]
    v_pk_fma_f32 v[92:93], v[146:147], v[16:17], v[112:113] op_sel:[0,0,0] op_sel_hi:[0,1,1]
    v_pk_fma_f32 v[96:97], v[148:149], v[24:25], v[116:117] op_sel:[0,0,0] op_sel_hi:[0,1,1]
    v_pk_fma_f32 v[100:101], v[150:151], v[32:33], v[120:121] op_sel:[0,0,0] op_sel_hi:[0,1,1]
    v_pk_fma_f32 v[104:105], v[152:153], v[40:41], v[124:125] op_sel:[0,0,0] op_sel_hi:[0,1,1]
    v_pk_fma_f32 v[90:91], v[144:145], v[48:49], v[110:111] op_sel:[0,0,0] op_sel_hi:[0,1,1]
    v_pk_fma_f32 v[94:95], v[146:147], v[56:57], v[114:115] op_sel:[0,0,0] op_sel_hi:[0,1,1]
    v_pk_fma_f32 v[98:99], v[148:149], v[64:65], v[118:119] op_sel:[0,0,0] op_sel_hi:[0,1,1]
    v_pk_fma_f32 v[102:103], v[150:151], v[72:73], v[122:123] op_sel:[0,0,0] op_sel_hi:[0,1,1]
    v_pk_fma_f32 v[106:107], v[152:153], v[80:81], v[126:127] op_sel:[0,0,0] op_sel_hi:[0,1,1]
    v_pk_fma_f32 v[108:109], v[144:145], v[90:91], v[12:13] op_sel:[1,0,0] op_sel_hi:[1,1,1] neg_lo:[1,0,0] neg_hi:[1,0,0]
    v_pk_fma_f32 v[112:113], v[146:147], v[94:95], v[20:21] op_sel:[1,0,0] op_sel_hi:[1,1,1] neg_lo:[1,0,0] neg_hi:[1,0,0]
    v_pk_fma_f32 v[116:117], v[148:149], v[98:99], v[28:29] op_sel:[1,0,0] op_sel_hi:[1,1,1] neg_lo:[1,0,0] neg_hi:[1,0,0]
    v_pk_fma_f32 v[120:121], v[150:151], v[102:103], v[36:37] op_sel:[1,0,0] op_sel_hi:[1,1,1] neg_lo:[1,0,0] neg_hi:[1,0,0]
    v_pk_fma_f32 v[124:125], v[152:153], v[106:107], v[44:45] op_sel:[1,0,0] op_sel_hi:[1,1,1] neg_lo:[1,0,0] neg_hi:[1,0,0]
    v_pk_fma_f32 v[110:111], v[144:145], v[88:89], v[52:53] op_sel:[1,0,0] op_sel_hi:[1,1,1]
    v_pk_fma_f32 v[114:115], v[146:147], v[92:93], v[60:61] op_sel:[1,0,0] op_sel_hi:[1,1,1]
    v_pk_fma_f32 v[118:119], v[148:149], v[96:97], v[68:69] op_sel:[1,0,0] op_sel_hi:[1,1,1]
    v_pk_fma_f32 v[122:123], v[150:151], v[100:101], v[76:77] op_sel:[1,0,0] op_sel_hi:[1,1,1]
    v_pk_fma_f32 v[126:127], v[152:153], v[104:105], v[84:85] op_sel:[1,0,0] op_sel_hi:[1,1,1]
    v_pk_fma_f32 v[88:89], v[144:145], v[88:89], v[108:109] op_sel:[0,0,0] op_sel_hi:[0,1,1]
    v_pk_fma_f32 v[92:93], v[146:147], v[92:93], v[112:113] op_sel:[0,0,0] op_sel_hi:[0,1,1]
    v_pk_fma_f32 v[96:97], v[148:149], v[96:97], v[116:117] op_sel:[0,0,0] op_sel_hi:[0,1,1]
    v_pk_fma_f32 v[100:101], v[150:151], v[100:101], v[120:121] op_sel:[0,0,0] op_sel_hi:[0,1,1]
    v_pk_fma_f32 v[104:105], v[152:153], v[104:105], v[124:125] op_sel:[0,0,0] op_sel_hi:[0,1,1]
    v_pk_fma_f32 v[90:91], v[144:145], v[90:91], v[110:111] op_sel:[0,0,0] op_sel_hi:[0,1,1]
    v_pk_fma_f32 v[94:95], v[146:147], v[94:95], v[114:115] op_sel:[0,0,0] op_sel_hi:[0,1,1]
    v_pk_fma_f32 v[98:99], v[148:149], v[98:99], v[118:119] op_sel:[0,0,0] op_sel_hi:[0,1,1]
    v_pk_fma_f32 v[102:103], v[150:151], v[102:103], v[122:123] op_sel:[0,0,0] op_sel_hi:[0,1,1]
    v_pk_fma_f32 v[106:107], v[152:153], v[106:107], v[126:127] op_sel:[0,0,0] op_sel_hi:[0,1,1]
    v_pk_fma_f32 v[108:109], v[144:145], v[90:91], v[14:15] op_sel:[1,0,0] op_sel_hi:[1,1,1] neg_lo:[1,0,0] neg_hi:[1,0,0]
    v_pk_fma_f32 v[112:113], v[146:147], v[94:95], v[22:23] op_sel:[1,0,0] op_sel_hi:[1,1,1] neg_lo:[1,0,0] neg_hi:[1,0,0]
    v_pk_fma_f32 v[116:117], v[148:149], v[98:99], v[30:31] op_sel:[1,0,0] op_sel_hi:[1,1,1] neg_lo:[1,0,0] neg_hi:[1,0,0]
    v_pk_fma_f32 v[120:121], v[150:151], v[102:103], v[38:39] op_sel:[1,0,0] op_sel_hi:[1,1,1] neg_lo:[1,0,0] neg_hi:[1,0,0]
    v_pk_fma_f32 v[124:125], v[152:153], v[106:107], v[46:47] op_sel:[1,0,0] op_sel_hi:[1,1,1] neg_lo:[1,0,0] neg_hi:[1,0,0]
    v_pk_fma_f32 v[110:111], v[144:145], v[88:89], v[54:55] op_sel:[1,0,0] op_sel_hi:[1,1,1]
    v_pk_fma_f32 v[114:115], v[146:147], v[92:93], v[62:63] op_sel:[1,0,0] op_sel_hi:[1,1,1]
    v_pk_fma_f32 v[118:119], v[148:149], v[96:97], v[70:71] op_sel:[1,0,0] op_sel_hi:[1,1,1]
    v_pk_fma_f32 v[122:123], v[150:151], v[100:101], v[78:79] op_sel:[1,0,0] op_sel_hi:[1,1,1]
    v_pk_fma_f32 v[126:127], v[152:153], v[104:105], v[86:87] op_sel:[1,0,0] op_sel_hi:[1,1,1]
    v_pk_fma_f32 v[88:89], v[144:145], v[88:89], v[108:109] op_sel:[0,0,0] op_sel_hi:[0,1,1]
    v_pk_fma_f32 v[92:93], v[146:147], v[92:93], v[112:113] op_sel:[0,0,0] op_sel_hi:[0,1,1]
    v_pk_fma_f32 v[96:97], v[148:149], v[96:97], v[116:117] op_sel:[0,0,0] op_sel_hi:[0,1,1]
    v_pk_fma_f32 v[100:101], v[150:151], v[100:101], v[120:121] op_sel:[0,0,0] op_sel_hi:[0,1,1]
    v_pk_fma_f32 v[104:105], v[152:153], v[104:105], v[124:125] op_sel:[0,0,0] op_sel_hi:[0,1,1]
    v_pk_fma_f32 v[90:91], v[144:145], v[90:91], v[110:111] op_sel:[0,0,0] op_sel_hi:[0,1,1]
    v_pk_fma_f32 v[94:95], v[146:147], v[94:95], v[114:115] op_sel:[0,0,0] op_sel_hi:[0,1,1]
    v_pk_fma_f32 v[98:99], v[148:149], v[98:99], v[118:119] op_sel:[0,0,0] op_sel_hi:[0,1,1]
    v_pk_fma_f32 v[102:103], v[150:151], v[102:103], v[122:123] op_sel:[0,0,0] op_sel_hi:[0,1,1]
    v_pk_fma_f32 v[106:107], v[152:153], v[106:107], v[126:127] op_sel:[0,0,0] op_sel_hi:[0,1,1]
    v_fma_f32 v108, v194, v88, v89
    v_fma_f32 v110, v196, v92, v93
    v_fma_f32 v112, v198, v96, v97
    v_fma_f32 v114, v200, v100, v101
    v_fma_f32 v116, v202, v104, v105
    v_fma_f32 v109, v194, v90, v91
    v_fma_f32 v111, v196, v94, v95
    v_fma_f32 v113, v198, v98, v99
    v_fma_f32 v115, v200, v102, v103
    v_fma_f32 v117, v202, v106, v107
    v_fma_f32 v108, -v195, v90, v108
    v_fma_f32 v110, -v197, v94, v110
    v_fma_f32 v112, -v199, v98, v112
    v_fma_f32 v114, -v201, v102, v114
    v_fma_f32 v116, -v203, v106, v116
    v_fma_f32 v109, v195, v88, v109
    v_fma_f32 v111, v197, v92, v111
    v_fma_f32 v113, v199, v96, v113
    v_fma_f32 v115, v201, v100, v115
    v_fma_f32 v117, v203, v104, v117
    v_mov_b32 v138, 0
    v_mov_b32 v139, 0
    v_pk_mul_f32 v[128:129], v[214:215], v[108:109] op_sel:[0,0] op_sel_hi:[0,1]
    v_pk_mul_f32 v[130:131], v[216:217], v[110:111] op_sel:[0,0] op_sel_hi:[0,1]
    v_pk_mul_f32 v[132:133], v[218:219], v[112:113] op_sel:[0,0] op_sel_hi:[0,1]
    v_pk_mul_f32 v[134:135], v[220:221], v[114:115] op_sel:[0,0] op_sel_hi:[0,1]
    v_pk_mul_f32 v[136:137], v[222:223], v[116:117] op_sel:[0,0] op_sel_hi:[0,1]
    v_pk_fma_f32 v[128:129], v[214:215], v[108:109], v[128:129] op_sel:[1,1,0] op_sel_hi:[1,0,1] neg_lo:[1,0,0]
    v_pk_fma_f32 v[130:131], v[216:217], v[110:111], v[130:131] op_sel:[1,1,0] op_sel_hi:[1,0,1] neg_lo:[1,0,0]
    v_pk_fma_f32 v[132:133], v[218:219], v[112:113], v[132:133] op_sel:[1,1,0] op_sel_hi:[1,0,1] neg_lo:[1,0,0]
    v_pk_fma_f32 v[134:135], v[220:221], v[114:115], v[134:135] op_sel:[1,1,0] op_sel_hi:[1,0,1] neg_lo:[1,0,0]
    v_pk_fma_f32 v[136:137], v[222:223], v[116:117], v[136:137] op_sel:[1,1,0] op_sel_hi:[1,0,1] neg_lo:[1,0,0]
    v_permlane32_swap_b32 v128, v129
    v_permlane32_swap_b32 v130, v131
    v_permlane32_swap_b32 v132, v133
    v_permlane32_swap_b32 v134, v135
    v_permlane32_swap_b32 v136, v137
    v_permlane32_swap_b32 v138, v139
    v_add_f32 v128, v128, v129
    v_add_f32 v130, v130, v131
    v_add_f32 v132, v132, v133
    v_add_f32 v134, v134, v135
    v_add_f32 v136, v136, v137
    v_add_f32 v138, v138, v139
    v_permlane16_swap_b32 v128, v130
    v_permlane16_swap_b32 v132, v134
    v_permlane16_swap_b32 v136, v138
    v_add_f32 v128, v128, v130
    v_add_f32 v132, v132, v134
    v_add_f32 v136, v136, v138
    ds_write_b32 v6, v128 offset:10240
    ds_write_b32 v6, v132 offset:10256
    ds_write_b32 v6, v136 offset:10272
    ds_write_b64 v239, v[108:109] offset:0
    ds_write_b64 v239, v[110:111] offset:128
    ds_write_b64 v239, v[112:113] offset:256
    ds_write_b64 v239, v[114:115] offset:384
    ds_write_b64 v239, v[116:117] offset:512
    s_waitcnt lgkmcnt(0)
    s_barrier
    s_lshl_b32 s67, s35, 4
    s_add_u32 s67, s67, s52
    s_lshl_b32 s67, s67, 10
    s_add_u32 s67, s67, 4096
    s_lshl_b32 s64, s55, 7
    s_add_u32 s64, s64, s67
    s_add_u32 s67, s67, 512
    s_mov_b64 exec, 0xff
    v_lshlrev_b32 v250, 2, v0
    buffer_load_dword v252, v250, s[48:51], s64 offen sc1
    buffer_load_dword v251, v250, s[48:51], s67 offen sc1
    s_mov_b64 exec, -1
    ds_read_b64 v[118:119], v224 offset:0
    ds_read_b64 v[120:121], v224 offset:128
    ds_read_b64 v[122:123], v224 offset:256
    ds_read_b64 v[124:125], v224 offset:384
    ds_read_b64 v[126:127], v224 offset:512
    ds_read_b64 v[128:129], v224 offset:640
    ds_read_b64 v[130:131], v224 offset:768
    ds_read_b64 v[132:133], v224 offset:896
    ds_read_b64 v[134:135], v224 offset:1024
    ds_read_b64 v[136:137], v224 offset:1152
    v_mov_b64 v[108:109], 0
    v_mov_b64 v[110:111], 0
    v_mov_b64 v[112:113], 0
    v_mov_b64 v[114:115], 0
    v_mov_b64 v[116:117], 0
    s_mov_b32 s65, s55
    s_cmp_eq_u32 s55, 0
    s_cbranch_scc1 L_htail_46
L_horner_45:
    ds_read_b64 v[214:215], v224 offset:1280
    ds_read_b64 v[216:217], v224 offset:1408
    ds_read_b64 v[218:219], v224 offset:1536
    ds_read_b64 v[220:221], v224 offset:1664
    ds_read_b64 v[222:223], v224 offset:1792
    s_waitcnt lgkmcnt(10)
    v_pk_fma_f32 v[118:119], v[204:205], v[108:109], v[118:119] op_sel:[0,0,0] op_sel_hi:[0,1,1]
    v_pk_fma_f32 v[120:121], v[206:207], v[110:111], v[120:121] op_sel:[0,0,0] op_sel_hi:[0,1,1]
    v_pk_fma_f32 v[122:123], v[208:209], v[112:113], v[122:123] op_sel:[0,0,0] op_sel_hi:[0,1,1]
    v_pk_fma_f32 v[124:125], v[210:211], v[114:115], v[124:125] op_sel:[0,0,0] op_sel_hi:[0,1,1]
    v_pk_fma_f32 v[126:127], v[212:213], v[116:117], v[126:127] op_sel:[0,0,0] op_sel_hi:[0,1,1]
    v_pk_fma_f32 v[118:119], v[204:205], v[108:109], v[118:119] op_sel:[1,1,0] op_sel_hi:[1,0,1] neg_lo:[1,0,0]
    v_pk_fma_f32 v[120:121], v[206:207], v[110:111], v[120:121] op_sel:[1,1,0] op_sel_hi:[1,0,1] neg_lo:[1,0,0]
    v_pk_fma_f32 v[122:123], v[208:209], v[112:113], v[122:123] op_sel:[1,1,0] op_sel_hi:[1,0,1] neg_lo:[1,0,0]
    v_pk_fma_f32 v[124:125], v[210:211], v[114:115], v[124:125] op_sel:[1,1,0] op_sel_hi:[1,0,1] neg_lo:[1,0,0]
    v_pk_fma_f32 v[126:127], v[212:213], v[116:117], v[126:127] op_sel:[1,1,0] op_sel_hi:[1,0,1] neg_lo:[1,0,0]
    ds_read_b64 v[108:109], v224 offset:1920
    ds_read_b64 v[110:111], v224 offset:2048
    ds_read_b64 v[112:113], v224 offset:2176
    ds_read_b64 v[114:115], v224 offset:2304
    ds_read_b64 v[116:117], v224 offset:2432
    s_waitcnt lgkmcnt(10)
    v_pk_fma_f32 v[128:129], v[204:205], v[118:119], v[128:129] op_sel:[0,0,0] op_sel_hi:[0,1,1]
    v_pk_fma_f32 v[130:131], v[206:207], v[120:121], v[130:131] op_sel:[0,0,0] op_sel_hi:[0,1,1]
    v_pk_fma_f32 v[132:133], v[208:209], v[122:123], v[132:133] op_sel:[0,0,0] op_sel_hi:[0,1,1]
    v_pk_fma_f32 v[134:135], v[210:211], v[124:125], v[134:135] op_sel:[0,0,0] op_sel_hi:[0,1,1]
    v_pk_fma_f32 v[136:137], v[212:213], v[126:127], v[136:137] op_sel:[0,0,0] op_sel_hi:[0,1,1]
    v_pk_fma_f32 v[128:129], v[204:205], v[118:119], v[128:129] op_sel:[1,1,0] op_sel_hi:[1,0,1] neg_lo:[1,0,0]
    v_pk_fma_f32 v[130:131], v[206:207], v[120:121], v[130:131] op_sel:[1,1,0] op_sel_hi:[1,0,1] neg_lo:[1,0,0]
    v_pk_fma_f32 v[132:133], v[208:209], v[122:123], v[132:133] op_sel:[1,1,0] op_sel_hi:[1,0,1] neg_lo:[1,0,0]
    v_pk_fma_f32 v[134:135], v[210:211], v[124:125], v[134:135] op_sel:[1,1,0] op_sel_hi:[1,0,1] neg_lo:[1,0,0]
    v_pk_fma_f32 v[136:137], v[212:213], v[126:127], v[136:137] op_sel:[1,1,0] op_sel_hi:[1,0,1] neg_lo:[1,0,0]
    ds_read_b64 v[118:119], v224 offset:2560
    ds_read_b64 v[120:121], v224 offset:2688
    ds_read_b64 v[122:123], v224 offset:2816
    ds_read_b64 v[124:125], v224 offset:2944
    ds_read_b64 v[126:127], v224 offset:3072
    s_waitcnt lgkmcnt(10)
    v_pk_fma_f32 v[214:215], v[204:205], v[128:129], v[214:215] op_sel:[0,0,0] op_sel_hi:[0,1,1]
    v_pk_fma_f32 v[216:217], v[206:207], v[130:131], v[216:217] op_sel:[0,0,0] op_sel_hi:[0,1,1]
    v_pk_fma_f32 v[218:219], v[208:209], v[132:133], v[218:219] op_sel:[0,0,0] op_sel_hi:[0,1,1]
    v_pk_fma_f32 v[220:221], v[210:211], v[134:135], v[220:221] op_sel:[0,0,0] op_sel_hi:[0,1,1]
    v_pk_fma_f32 v[222:223], v[212:213], v[136:137], v[222:223] op_sel:[0,0,0] op_sel_hi:[0,1,1]
    v_pk_fma_f32 v[214:215], v[204:205], v[128:129], v[214:215] op_sel:[1,1,0] op_sel_hi:[1,0,1] neg_lo:[1,0,0]
    v_pk_fma_f32 v[216:217], v[206:207], v[130:131], v[216:217] op_sel:[1,1,0] op_sel_hi:[1,0,1] neg_lo:[1,0,0]
    v_pk_fma_f32 v[218:219], v[208:209], v[132:133], v[218:219] op_sel:[1,1,0] op_sel_hi:[1,0,1] neg_lo:[1,0,0]
    v_pk_fma_f32 v[220:221], v[210:211], v[134:135], v[220:221] op_sel:[1,1,0] op_sel_hi:[1,0,1] neg_lo:[1,0,0]
    v_pk_fma_f32 v[222:223], v[212:213], v[136:137], v[222:223] op_sel:[1,1,0] op_sel_hi:[1,0,1] neg_lo:[1,0,0]
    ds_read_b64 v[128:129], v224 offset:3200
    ds_read_b64 v[130:131], v224 offset:3328
    ds_read_b64 v[132:133], v224 offset:3456
    ds_read_b64 v[134:135], v224 offset:3584
    ds_read_b64 v[136:137], v224 offset:3712
    s_waitcnt lgkmcnt(10)
    v_pk_fma_f32 v[108:109], v[204:205], v[214:215], v[108:109] op_sel:[0,0,0] op_sel_hi:[0,1,1]
    v_pk_fma_f32 v[110:111], v[206:207], v[216:217], v[110:111] op_sel:[0,0,0] op_sel_hi:[0,1,1]
    v_pk_fma_f32 v[112:113], v[208:209], v[218:219], v[112:113] op_sel:[0,0,0] op_sel_hi:[0,1,1]
    v_pk_fma_f32 v[114:115], v[210:211], v[220:221], v[114:115] op_sel:[0,0,0] op_sel_hi:[0,1,1]
    v_pk_fma_f32 v[116:117], v[212:213], v[222:223], v[116:117] op_sel:[0,0,0] op_sel_hi:[0,1,1]
    v_pk_fma_f32 v[108:109], v[204:205], v[214:215], v[108:109] op_sel:[1,1,0] op_sel_hi:[1,0,1] neg_lo:[1,0,0]
    v_pk_fma_f32 v[110:111], v[206:207], v[216:217], v[110:111] op_sel:[1,1,0] op_sel_hi:[1,0,1] neg_lo:[1,0,0]
    v_pk_fma_f32 v[112:113], v[208:209], v[218:219], v[112:113] op_sel:[1,1,0] op_sel_hi:[1,0,1] neg_lo:[1,0,0]
    v_pk_fma_f32 v[114:115], v[210:211], v[220:221], v[114:115] op_sel:[1,1,0] op_sel_hi:[1,0,1] neg_lo:[1,0,0]
    v_pk_fma_f32 v[116:117], v[212:213], v[222:223], v[116:117] op_sel:[1,1,0] op_sel_hi:[1,0,1] neg_lo:[1,0,0]
    v_add_u32 v224, 2560, v224
    s_sub_u32 s65, s65, 1
    s_cmp_lg_u32 s65, 0
    s_cbranch_scc1 L_horner_45
L_htail_46:
    ds_read_b64 v[214:215], v224 offset:1280
    ds_read_b64 v[216:217], v224 offset:1408
    ds_read_b64 v[218:219], v224 offset:1536
    ds_read_b64 v[220:221], v224 offset:1664
    ds_read_b64 v[222:223], v224 offset:1792
    s_waitcnt lgkmcnt(10)
    s_mov_b32 exec_lo, 0xffff0000
    s_mov_b32 exec_hi, 0xffffffff
    v_pk_fma_f32 v[118:119], v[204:205], v[108:109], v[118:119] op_sel:[0,0,0] op_sel_hi:[0,1,1]
    v_pk_fma_f32 v[120:121], v[206:207], v[110:111], v[120:121] op_sel:[0,0,0] op_sel_hi:[0,1,1]
    v_pk_fma_f32 v[122:123], v[208:209], v[112:113], v[122:123] op_sel:[0,0,0] op_sel_hi:[0,1,1]
    v_pk_fma_f32 v[124:125], v[210:211], v[114:115], v[124:125] op_sel:[0,0,0] op_sel_hi:[0,1,1]
    v_pk_fma_f32 v[126:127], v[212:213], v[116:117], v[126:127] op_sel:[0,0,0] op_sel_hi:[0,1,1]
    v_pk_fma_f32 v[118:119], v[204:205], v[108:109], v[118:119] op_sel:[1,1,0] op_sel_hi:[1,0,1] neg_lo:[1,0,0]
    v_pk_fma_f32 v[120:121], v[206:207], v[110:111], v[120:121] op_sel:[1,1,0] op_sel_hi:[1,0,1] neg_lo:[1,0,0]
    v_pk_fma_f32 v[122:123], v[208:209], v[112:113], v[122:123] op_sel:[1,1,0] op_sel_hi:[1,0,1] neg_lo:[1,0,0]
    v_pk_fma_f32 v[124:125], v[210:211], v[114:115], v[124:125] op_sel:[1,1,0] op_sel_hi:[1,0,1] neg_lo:[1,0,0]
    v_pk_fma_f32 v[126:127], v[212:213], v[116:117], v[126:127] op_sel:[1,1,0] op_sel_hi:[1,0,1] neg_lo:[1,0,0]
    v_mov_b64 v[108:109], v[118:119]
    v_mov_b64 v[110:111], v[120:121]
    v_mov_b64 v[112:113], v[122:123]
    v_mov_b64 v[114:115], v[124:125]
    v_mov_b64 v[116:117], v[126:127]
    s_waitcnt lgkmcnt(5)
    s_mov_b32 exec_lo, 0x0
    s_mov_b32 exec_hi, 0xffffffff
    v_pk_fma_f32 v[128:129], v[204:205], v[108:109], v[128:129] op_sel:[0,0,0] op_sel_hi:[0,1,1]
    v_pk_fma_f32 v[130:131], v[206:207], v[110:111], v[130:131] op_sel:[0,0,0] op_sel_hi:[0,1,1]
    v_pk_fma_f32 v[132:133], v[208:209], v[112:113], v[132:133] op_sel:[0,0,0] op_sel_hi:[0,1,1]
    v_pk_fma_f32 v[134:135], v[210:211], v[114:115], v[134:135] op_sel:[0,0,0] op_sel_hi:[0,1,1]
    v_pk_fma_f32 v[136:137], v[212:213], v[116:117], v[136:137] op_sel:[0,0,0] op_sel_hi:[0,1,1]
    v_pk_fma_f32 v[128:129], v[204:205], v[108:109], v[128:129] op_sel:[1,1,0] op_sel_hi:[1,0,1] neg_lo:[1,0,0]
    v_pk_fma_f32 v[130:131], v[206:207], v[110:111], v[130:131] op_sel:[1,1,0] op_sel_hi:[1,0,1] neg_lo:[1,0,0]
    v_pk_fma_f32 v[132:133], v[208:209], v[112:113], v[132:133] op_sel:[1,1,0] op_sel_hi:[1,0,1] neg_lo:[1,0,0]
    v_pk_fma_f32 v[134:135], v[210:211], v[114:115], v[134:135] op_sel:[1,1,0] op_sel_hi:[1,0,1] neg_lo:[1,0,0]
    v_pk_fma_f32 v[136:137], v[212:213], v[116:117], v[136:137] op_sel:[1,1,0] op_sel_hi:[1,0,1] neg_lo:[1,0,0]
    v_mov_b64 v[108:109], v[128:129]
    v_mov_b64 v[110:111], v[130:131]
    v_mov_b64 v[112:113], v[132:133]
    v_mov_b64 v[114:115], v[134:135]
    v_mov_b64 v[116:117], v[136:137]
    s_waitcnt lgkmcnt(0)
    s_mov_b32 exec_lo, 0x0
    s_mov_b32 exec_hi, 0xffff0000
    v_pk_fma_f32 v[214:215], v[204:205], v[108:109], v[214:215] op_sel:[0,0,0] op_sel_hi:[0,1,1]
    v_pk_fma_f32 v[216:217], v[206:207], v[110:111], v[216:217] op_sel:[0,0,0] op_sel_hi:[0,1,1]
    v_pk_fma_f32 v[218:219], v[208:209], v[112:113], v[218:219] op_sel:[0,0,0] op_sel_hi:[0,1,1]
    v_pk_fma_f32 v[220:221], v[210:211], v[114:115], v[220:221] op_sel:[0,0,0] op_sel_hi:[0,1,1]
    v_pk_fma_f32 v[222:223], v[212:213], v[116:117], v[222:223] op_sel:[0,0,0] op_sel_hi:[0,1,1]
    v_pk_fma_f32 v[214:215], v[204:205], v[108:109], v[214:215] op_sel:[1,1,0] op_sel_hi:[1,0,1] neg_lo:[1,0,0]
    v_pk_fma_f32 v[216:217], v[206:207], v[110:111], v[216:217] op_sel:[1,1,0] op_sel_hi:[1,0,1] neg_lo:[1,0,0]
    v_pk_fma_f32 v[218:219], v[208:209], v[112:113], v[218:219] op_sel:[1,1,0] op_sel_hi:[1,0,1] neg_lo:[1,0,0]
    v_pk_fma_f32 v[220:221], v[210:211], v[114:115], v[220:221] op_sel:[1,1,0] op_sel_hi:[1,0,1] neg_lo:[1,0,0]
    v_pk_fma_f32 v[222:223], v[212:213], v[116:117], v[222:223] op_sel:[1,1,0] op_sel_hi:[1,0,1] neg_lo:[1,0,0]
    v_mov_b64 v[108:109], v[214:215]
    v_mov_b64 v[110:111], v[216:217]
    v_mov_b64 v[112:113], v[218:219]
    v_mov_b64 v[114:115], v[220:221]
    v_mov_b64 v[116:117], v[222:223]
    s_mov_b64 exec, -1
    v_fma_f32 v118, v194, v108, v88
    v_fma_f32 v120, v196, v110, v92
    v_fma_f32 v122, v198, v112, v96
    v_fma_f32 v124, v200, v114, v100
    v_fma_f32 v126, v202, v116, v104
    v_fma_f32 v119, v194, v109, v90
    v_fma_f32 v121, v196, v111, v94
    v_fma_f32 v123, v198, v113, v98
    v_fma_f32 v125, v200, v115, v102
    v_fma_f32 v127, v202, v117, v106
    v_fma_f32 v118, -v195, v109, v118
    v_fma_f32 v120, -v197, v111, v120
    v_fma_f32 v122, -v199, v113, v122
    v_fma_f32 v124, -v201, v115, v124
    v_fma_f32 v126, -v203, v117, v126
    v_fma_f32 v119, v195, v108, v119
    v_fma_f32 v121, v197, v110, v121
    v_fma_f32 v123, v199, v112, v123
    v_fma_f32 v125, v201, v114, v125
    v_fma_f32 v127, v203, v116, v127
    v_mul_f32 v88, v154, v108
    v_mul_f32 v92, v156, v110
    v_mul_f32 v96, v158, v112
    v_mul_f32 v100, v160, v114
    v_mul_f32 v104, v162, v116
    v_mul_f32 v90, v154, v109
    v_mul_f32 v94, v156, v111
    v_mul_f32 v98, v158, v113
    v_mul_f32 v102, v160, v115
    v_mul_f32 v106, v162, v117
    v_fma_f32 v88, -v155, v109, v88
    v_fma_f32 v92, -v157, v111, v92
    v_fma_f32 v96, -v159, v113, v96
    v_fma_f32 v100, -v161, v115, v100
    v_fma_f32 v104, -v163, v117, v104
    v_fma_f32 v90, v155, v108, v90
    v_fma_f32 v94, v157, v110, v94
    v_fma_f32 v98, v159, v112, v98
    v_fma_f32 v102, v161, v114, v102
    v_fma_f32 v106, v163, v116, v106
    v_mul_f32 v89, v154, v118
    v_mul_f32 v93, v156, v120
    v_mul_f32 v97, v158, v122
    v_mul_f32 v101, v160, v124
    v_mul_f32 v105, v162, v126
    v_mul_f32 v91, v154, v119
    v_mul_f32 v95, v156, v121
    v_mul_f32 v99, v158, v123
    v_mul_f32 v103, v160, v125
    v_mul_f32 v107, v162, v127
    v_fma_f32 v89, -v155, v119, v89
    v_fma_f32 v93, -v157, v121, v93
    v_fma_f32 v97, -v159, v123, v97
    v_fma_f32 v101, -v161, v125, v101
    v_fma_f32 v105, -v163, v127, v105
    v_fma_f32 v91, v155, v118, v91
    v_fma_f32 v95, v157, v120, v95
    v_fma_f32 v99, v159, v122, v99
    v_fma_f32 v103, v161, v124, v103
    v_fma_f32 v107, v163, v126, v107
    v_mov_b64 v[128:129], 0
    v_mov_b64 v[130:131], 0
    v_mov_b64 v[132:133], 0
    v_mov_b64 v[134:135], 0
    v_mov_b64 v[136:137], 0
    v_mov_b64 v[138:139], 0
    v_pk_mul_f32 v[108:109], v[154:155], v[48:49] op_sel:[1,0] op_sel_hi:[1,1]
    v_pk_mul_f32 v[112:113], v[156:157], v[56:57] op_sel:[1,0] op_sel_hi:[1,1]
    v_pk_mul_f32 v[116:117], v[158:159], v[64:65] op_sel:[1,0] op_sel_hi:[1,1]
    v_pk_mul_f32 v[120:121], v[160:161], v[72:73] op_sel:[1,0] op_sel_hi:[1,1]
    v_pk_mul_f32 v[124:125], v[162:163], v[80:81] op_sel:[1,0] op_sel_hi:[1,1]
    v_pk_mul_f32 v[110:111], v[154:155], v[8:9] op_sel:[1,0] op_sel_hi:[1,1]
    v_pk_mul_f32 v[114:115], v[156:157], v[16:17] op_sel:[1,0] op_sel_hi:[1,1]
    v_pk_mul_f32 v[118:119], v[158:159], v[24:25] op_sel:[1,0] op_sel_hi:[1,1]
    v_pk_mul_f32 v[122:123], v[160:161], v[32:33] op_sel:[1,0] op_sel_hi:[1,1]
    v_pk_mul_f32 v[126:127], v[162:163], v[40:41] op_sel:[1,0] op_sel_hi:[1,1]
    v_pk_fma_f32 v[8:9], v[154:155], v[8:9], v[108:109] op_sel:[0,0,0] op_sel_hi:[0,1,1] neg_lo:[0,0,1] neg_hi:[0,0,1]
    v_pk_fma_f32 v[16:17], v[156:157], v[16:17], v[112:113] op_sel:[0,0,0] op_sel_hi:[0,1,1] neg_lo:[0,0,1] neg_hi:[0,0,1]
    v_pk_fma_f32 v[24:25], v[158:159], v[24:25], v[116:117] op_sel:[0,0,0] op_sel_hi:[0,1,1] neg_lo:[0,0,1] neg_hi:[0,0,1]
    v_pk_fma_f32 v[32:33], v[160:161], v[32:33], v[120:121] op_sel:[0,0,0] op_sel_hi:[0,1,1] neg_lo:[0,0,1] neg_hi:[0,0,1]
    v_pk_fma_f32 v[40:41], v[162:163], v[40:41], v[124:125] op_sel:[0,0,0] op_sel_hi:[0,1,1] neg_lo:[0,0,1] neg_hi:[0,0,1]
    v_pk_fma_f32 v[48:49], v[154:155], v[48:49], v[110:111] op_sel:[0,0,0] op_sel_hi:[0,1,1]
    v_pk_fma_f32 v[56:57], v[156:157], v[56:57], v[114:115] op_sel:[0,0,0] op_sel_hi:[0,1,1]
    v_pk_fma_f32 v[64:65], v[158:159], v[64:65], v[118:119] op_sel:[0,0,0] op_sel_hi:[0,1,1]
    v_pk_fma_f32 v[72:73], v[160:161], v[72:73], v[122:123] op_sel:[0,0,0] op_sel_hi:[0,1,1]
    v_pk_fma_f32 v[80:81], v[162:163], v[80:81], v[126:127] op_sel:[0,0,0] op_sel_hi:[0,1,1]
    v_pk_mul_f32 v[108:109], v[154:155], v[50:51] op_sel:[1,0] op_sel_hi:[1,1]
    v_pk_mul_f32 v[112:113], v[156:157], v[58:59] op_sel:[1,0] op_sel_hi:[1,1]
    v_pk_mul_f32 v[116:117], v[158:159], v[66:67] op_sel:[1,0] op_sel_hi:[1,1]
    v_pk_mul_f32 v[120:121], v[160:161], v[74:75] op_sel:[1,0] op_sel_hi:[1,1]
    v_pk_mul_f32 v[124:125], v[162:163], v[82:83] op_sel:[1,0] op_sel_hi:[1,1]
    v_pk_mul_f32 v[110:111], v[154:155], v[10:11] op_sel:[1,0] op_sel_hi:[1,1]
    v_pk_mul_f32 v[114:115], v[156:157], v[18:19] op_sel:[1,0] op_sel_hi:[1,1]
    v_pk_mul_f32 v[118:119], v[158:159], v[26:27] op_sel:[1,0] op_sel_hi:[1,1]
    v_pk_mul_f32 v[122:123], v[160:161], v[34:35] op_sel:[1,0] op_sel_hi:[1,1]
    v_pk_mul_f32 v[126:127], v[162:163], v[42:43] op_sel:[1,0] op_sel_hi:[1,1]
    v_pk_fma_f32 v[10:11], v[154:155], v[10:11], v[108:109] op_sel:[0,0,0] op_sel_hi:[0,1,1] neg_lo:[0,0,1] neg_hi:[0,0,1]
    v_pk_fma_f32 v[18:19], v[156:157], v[18:19], v[112:113] op_sel:[0,0,0] op_sel_hi:[0,1,1] neg_lo:[0,0,1] neg_hi:[0,0,1]
    v_pk_fma_f32 v[26:27], v[158:159], v[26:27], v[116:117] op_sel:[0,0,0] op_sel_hi:[0,1,1] neg_lo:[0,0,1] neg_hi:[0,0,1]
    v_pk_fma_f32 v[34:35], v[160:161], v[34:35], v[120:121] op_sel:[0,0,0] op_sel_hi:[0,1,1] neg_lo:[0,0,1] neg_hi:[0,0,1]
    v_pk_fma_f32 v[42:43], v[162:163], v[42:43], v[124:125] op_sel:[0,0,0] op_sel_hi:[0,1,1] neg_lo:[0,0,1] neg_hi:[0,0,1]
    v_pk_fma_f32 v[50:51], v[154:155], v[50:51], v[110:111] op_sel:[0,0,0] op_sel_hi:[0,1,1]
    v_pk_fma_f32 v[58:59], v[156:157], v[58:59], v[114:115] op_sel:[0,0,0] op_sel_hi:[0,1,1]
    v_pk_fma_f32 v[66:67], v[158:159], v[66:67], v[118:119] op_sel:[0,0,0] op_sel_hi:[0,1,1]
    v_pk_fma_f32 v[74:75], v[160:161], v[74:75], v[122:123] op_sel:[0,0,0] op_sel_hi:[0,1,1]
    v_pk_fma_f32 v[82:83], v[162:163], v[82:83], v[126:127] op_sel:[0,0,0] op_sel_hi:[0,1,1]
    v_pk_mul_f32 v[108:109], v[154:155], v[52:53] op_sel:[1,0] op_sel_hi:[1,1]
    v_pk_mul_f32 v[112:113], v[156:157], v[60:61] op_sel:[1,0] op_sel_hi:[1,1]
    v_pk_mul_f32 v[116:117], v[158:159], v[68:69] op_sel:[1,0] op_sel_hi:[1,1]
    v_pk_mul_f32 v[120:121], v[160:161], v[76:77] op_sel:[1,0] op_sel_hi:[1,1]
    v_pk_mul_f32 v[124:125], v[162:163], v[84:85] op_sel:[1,0] op_sel_hi:[1,1]
    v_pk_mul_f32 v[110:111], v[154:155], v[12:13] op_sel:[1,0] op_sel_hi:[1,1]
    v_pk_mul_f32 v[114:115], v[156:157], v[20:21] op_sel:[1,0] op_sel_hi:[1,1]
    v_pk_mul_f32 v[118:119], v[158:159], v[28:29] op_sel:[1,0] op_sel_hi:[1,1]
    v_pk_mul_f32 v[122:123], v[160:161], v[36:37] op_sel:[1,0] op_sel_hi:[1,1]
    v_pk_mul_f32 v[126:127], v[162:163], v[44:45] op_sel:[1,0] op_sel_hi:[1,1]
    v_pk_fma_f32 v[12:13], v[154:155], v[12:13], v[108:109] op_sel:[0,0,0] op_sel_hi:[0,1,1] neg_lo:[0,0,1] neg_hi:[0,0,1]
    v_pk_fma_f32 v[20:21], v[156:157], v[20:21], v[112:113] op_sel:[0,0,0] op_sel_hi:[0,1,1] neg_lo:[0,0,1] neg_hi:[0,0,1]
    v_pk_fma_f32 v[28:29], v[158:159], v[28:29], v[116:117] op_sel:[0,0,0] op_sel_hi:[0,1,1] neg_lo:[0,0,1] neg_hi:[0,0,1]
    v_pk_fma_f32 v[36:37], v[160:161], v[36:37], v[120:121] op_sel:[0,0,0] op_sel_hi:[0,1,1] neg_lo:[0,0,1] neg_hi:[0,0,1]
    v_pk_fma_f32 v[44:45], v[162:163], v[44:45], v[124:125] op_sel:[0,0,0] op_sel_hi:[0,1,1] neg_lo:[0,0,1] neg_hi:[0,0,1]
    v_pk_fma_f32 v[52:53], v[154:155], v[52:53], v[110:111] op_sel:[0,0,0] op_sel_hi:[0,1,1]
    v_pk_fma_f32 v[60:61], v[156:157], v[60:61], v[114:115] op_sel:[0,0,0] op_sel_hi:[0,1,1]
    v_pk_fma_f32 v[68:69], v[158:159], v[68:69], v[118:119] op_sel:[0,0,0] op_sel_hi:[0,1,1]
    v_pk_fma_f32 v[76:77], v[160:161], v[76:77], v[122:123] op_sel:[0,0,0] op_sel_hi:[0,1,1]
    v_pk_fma_f32 v[84:85], v[162:163], v[84:85], v[126:127] op_sel:[0,0,0] op_sel_hi:[0,1,1]
    v_pk_mul_f32 v[108:109], v[154:155], v[54:55] op_sel:[1,0] op_sel_hi:[1,1]
    v_pk_mul_f32 v[112:113], v[156:157], v[62:63] op_sel:[1,0] op_sel_hi:[1,1]
    v_pk_mul_f32 v[116:117], v[158:159], v[70:71] op_sel:[1,0] op_sel_hi:[1,1]
    v_pk_mul_f32 v[120:121], v[160:161], v[78:79] op_sel:[1,0] op_sel_hi:[1,1]
    v_pk_mul_f32 v[124:125], v[162:163], v[86:87] op_sel:[1,0] op_sel_hi:[1,1]
    v_pk_mul_f32 v[110:111], v[154:155], v[14:15] op_sel:[1,0] op_sel_hi:[1,1]
    v_pk_mul_f32 v[114:115], v[156:157], v[22:23] op_sel:[1,0] op_sel_hi:[1,1]
    v_pk_mul_f32 v[118:119], v[158:159], v[30:31] op_sel:[1,0] op_sel_hi:[1,1]
    v_pk_mul_f32 v[122:123], v[160:161], v[38:39] op_sel:[1,0] op_sel_hi:[1,1]
    v_pk_mul_f32 v[126:127], v[162:163], v[46:47] op_sel:[1,0] op_sel_hi:[1,1]
    v_pk_fma_f32 v[14:15], v[154:155], v[14:15], v[108:109] op_sel:[0,0,0] op_sel_hi:[0,1,1] neg_lo:[0,0,1] neg_hi:[0,0,1]
    v_pk_fma_f32 v[22:23], v[156:157], v[22:23], v[112:113] op_sel:[0,0,0] op_sel_hi:[0,1,1] neg_lo:[0,0,1] neg_hi:[0,0,1]
    v_pk_fma_f32 v[30:31], v[158:159], v[30:31], v[116:117] op_sel:[0,0,0] op_sel_hi:[0,1,1] neg_lo:[0,0,1] neg_hi:[0,0,1]
    v_pk_fma_f32 v[38:39], v[160:161], v[38:39], v[120:121] op_sel:[0,0,0] op_sel_hi:[0,1,1] neg_lo:[0,0,1] neg_hi:[0,0,1]
    v_pk_fma_f32 v[46:47], v[162:163], v[46:47], v[124:125] op_sel:[0,0,0] op_sel_hi:[0,1,1] neg_lo:[0,0,1] neg_hi:[0,0,1]
    v_pk_fma_f32 v[54:55], v[154:155], v[54:55], v[110:111] op_sel:[0,0,0] op_sel_hi:[0,1,1]
    v_pk_fma_f32 v[62:63], v[156:157], v[62:63], v[114:115] op_sel:[0,0,0] op_sel_hi:[0,1,1]
    v_pk_fma_f32 v[70:71], v[158:159], v[70:71], v[118:119] op_sel:[0,0,0] op_sel_hi:[0,1,1]
    v_pk_fma_f32 v[78:79], v[160:161], v[78:79], v[122:123] op_sel:[0,0,0] op_sel_hi:[0,1,1]
    v_pk_fma_f32 v[86:87], v[162:163], v[86:87], v[126:127] op_sel:[0,0,0] op_sel_hi:[0,1,1]
    s_lshr_b32 s69, s56, 8
    s_lshr_b32 s70, s56, 16
    s_lshr_b32 s71, s56, 24
    s_mov_b32 s66, 0
    s_mov_b64 exec, s[74:75]
    s_cbranch_execz L_bgn_50
L_bgp_47:
    buffer_load_dwordx4 v[128:131], v226, s[48:51], s90 offen offset:0 sc1
    buffer_load_dwordx4 v[132:135], v226, s[48:51], s90 offen offset:256 sc1
    buffer_load_dwordx4 v[136:139], v226, s[48:51], s90 offen offset:512 sc1
L_bgc_48:
    s_waitcnt vmcnt(2)
    v_xor_b32 v253, s56, v128
    v_bitop3_b32 v253, v253, s69, v129 bitop3:0xf6
    v_bitop3_b32 v253, v253, s70, v130 bitop3:0xf6
    v_bitop3_b32 v253, v253, s71, v131 bitop3:0xf6
    s_waitcnt vmcnt(1)
    v_bitop3_b32 v253, v253, s56, v132 bitop3:0xf6
    v_bitop3_b32 v253, v253, s69, v133 bitop3:0xf6
    v_bitop3_b32 v253, v253, s70, v134 bitop3:0xf6
    v_bitop3_b32 v253, v253, s71, v135 bitop3:0xf6
    s_waitcnt vmcnt(0)
    v_bitop3_b32 v253, v253, s56, v136 bitop3:0xf6
    v_bitop3_b32 v253, v253, s69, v137 bitop3:0xf6
    v_bitop3_b32 v253, v253, s70, v138 bitop3:0xf6
    v_bitop3_b32 v253, v253, s71, v139 bitop3:0xf6
    v_and_b32 v253, 0xff, v253
    v_cmp_ne_u32 vcc, 0, v253
    s_cbranch_vccz L_bgok_49
    s_add_u32 s66, s66, 1
    s_cmp_lt_u32 s66, 200000
    s_cbranch_scc1 L_bgp_47
L_bgok_49:
L_bgn_50:
    s_mov_b64 exec, -1
    s_movk_i32 s59, 0xff00
    v_and_b32 v128, s59, v128
    v_and_b32 v129, s59, v129
    v_and_b32 v130, s59, v130
    v_and_b32 v131, s59, v131
    v_and_b32 v132, s59, v132
    v_and_b32 v133, s59, v133
    v_and_b32 v134, s59, v134
    v_and_b32 v135, s59, v135
    v_and_b32 v136, s59, v136
    v_and_b32 v137, s59, v137
    v_mov_b32 v118, 0
    v_mov_b32 v119, 0
    v_pk_mul_f32 v[108:109], v[184:185], v[128:129] op_sel:[0,0] op_sel_hi:[0,1]
    v_pk_mul_f32 v[110:111], v[186:187], v[130:131] op_sel:[0,0] op_sel_hi:[0,1]
    v_pk_mul_f32 v[112:113], v[188:189], v[132:133] op_sel:[0,0] op_sel_hi:[0,1]
    v_pk_mul_f32 v[114:115], v[190:191], v[134:135] op_sel:[0,0] op_sel_hi:[0,1]
    v_pk_mul_f32 v[116:117], v[192:193], v[136:137] op_sel:[0,0] op_sel_hi:[0,1]
    v_pk_fma_f32 v[108:109], v[184:185], v[128:129], v[108:109] op_sel:[1,1,0] op_sel_hi:[1,0,1] neg_lo:[1,0,0]
    v_pk_fma_f32 v[110:111], v[186:187], v[130:131], v[110:111] op_sel:[1,1,0] op_sel_hi:[1,0,1] neg_lo:[1,0,0]
    v_pk_fma_f32 v[112:113], v[188:189], v[132:133], v[112:113] op_sel:[1,1,0] op_sel_hi:[1,0,1] neg_lo:[1,0,0]
    v_pk_fma_f32 v[114:115], v[190:191], v[134:135], v[114:115] op_sel:[1,1,0] op_sel_hi:[1,0,1] neg_lo:[1,0,0]
    v_pk_fma_f32 v[116:117], v[192:193], v[136:137], v[116:117] op_sel:[1,1,0] op_sel_hi:[1,0,1] neg_lo:[1,0,0]
    v_permlane32_swap_b32 v108, v109
    v_permlane32_swap_b32 v110, v111
    v_permlane32_swap_b32 v112, v113
    v_permlane32_swap_b32 v114, v115
    v_permlane32_swap_b32 v116, v117
    v_permlane32_swap_b32 v118, v119
    v_add_f32 v108, v108, v109
    v_add_f32 v110, v110, v111
    v_add_f32 v112, v112, v113
    v_add_f32 v114, v114, v115
    v_add_f32 v116, v116, v117
    v_add_f32 v118, v118, v119
    v_permlane16_swap_b32 v108, v110
    v_permlane16_swap_b32 v112, v114
    v_permlane16_swap_b32 v116, v118
    v_add_f32 v108, v108, v110
    v_add_f32 v112, v112, v114
    v_add_f32 v116, v116, v118
    ds_write_b32 v6, v108 offset:13312
    ds_write_b32 v6, v112 offset:13328
    ds_write_b32 v6, v116 offset:13344
    s_waitcnt lgkmcnt(0)
    s_barrier
    ds_read_b128 v[108:111], v5 offset:13312
    ds_read_b128 v[112:115], v5 offset:13328
    ds_read_b128 v[116:119], v5 offset:13344
    ds_read_b128 v[120:123], v5 offset:14080
    ds_read_b128 v[124:127], v5 offset:14096
    ds_read_b128 v[128:131], v5 offset:14112
    ds_read_b128 v[132:135], v5 offset:14848
    ds_read_b128 v[136:139], v5 offset:14864
    ds_read_b128 v[140:143], v5 offset:14880
    ds_read_b128 v[184:187], v5 offset:15616
    ds_read_b128 v[188:191], v5 offset:15632
    ds_read_b128 v[192:195], v5 offset:15648
    s_waitcnt lgkmcnt(6)
    v_pk_add_f32 v[108:109], v[108:109], v[120:121]
    v_pk_add_f32 v[110:111], v[110:111], v[122:123]
    v_pk_add_f32 v[112:113], v[112:113], v[124:125]
    v_pk_add_f32 v[114:115], v[114:115], v[126:127]
    v_pk_add_f32 v[116:117], v[116:117], v[128:129]
    s_waitcnt lgkmcnt(0)
    v_pk_add_f32 v[132:133], v[132:133], v[184:185]
    v_pk_add_f32 v[134:135], v[134:135], v[186:187]
    v_pk_add_f32 v[136:137], v[136:137], v[188:189]
    v_pk_add_f32 v[138:139], v[138:139], v[190:191]
    v_pk_add_f32 v[140:141], v[140:141], v[192:193]
    v_pk_add_f32 v[108:109], v[108:109], v[132:133]
    v_pk_add_f32 v[110:111], v[110:111], v[134:135]
    v_pk_add_f32 v[112:113], v[112:113], v[136:137]
    v_pk_add_f32 v[114:115], v[114:115], v[138:139]
    v_pk_add_f32 v[116:117], v[116:117], v[140:141]
    v_pk_fma_f32 v[88:89], v[164:165], v[108:109], v[88:89] op_sel:[0,0,0] op_sel_hi:[1,0,1]
    v_pk_fma_f32 v[92:93], v[168:169], v[110:111], v[92:93] op_sel:[0,0,0] op_sel_hi:[1,0,1]
    v_pk_fma_f32 v[96:97], v[172:173], v[112:113], v[96:97] op_sel:[0,0,0] op_sel_hi:[1,0,1]
    v_pk_fma_f32 v[100:101], v[176:177], v[114:115], v[100:101] op_sel:[0,0,0] op_sel_hi:[1,0,1]
    v_pk_fma_f32 v[104:105], v[180:181], v[116:117], v[104:105] op_sel:[0,0,0] op_sel_hi:[1,0,1]
    v_pk_fma_f32 v[90:91], v[164:165], v[108:109], v[90:91] op_sel:[0,1,0] op_sel_hi:[1,1,1]
    v_pk_fma_f32 v[94:95], v[168:169], v[110:111], v[94:95] op_sel:[0,1,0] op_sel_hi:[1,1,1]
    v_pk_fma_f32 v[98:99], v[172:173], v[112:113], v[98:99] op_sel:[0,1,0] op_sel_hi:[1,1,1]
    v_pk_fma_f32 v[102:103], v[176:177], v[114:115], v[102:103] op_sel:[0,1,0] op_sel_hi:[1,1,1]
    v_pk_fma_f32 v[106:107], v[180:181], v[116:117], v[106:107] op_sel:[0,1,0] op_sel_hi:[1,1,1]
    v_pk_fma_f32 v[88:89], v[166:167], v[108:109], v[88:89] op_sel:[0,1,0] op_sel_hi:[1,1,1] neg_lo:[1,0,0] neg_hi:[1,0,0]
    v_pk_fma_f32 v[92:93], v[170:171], v[110:111], v[92:93] op_sel:[0,1,0] op_sel_hi:[1,1,1] neg_lo:[1,0,0] neg_hi:[1,0,0]
    v_pk_fma_f32 v[96:97], v[174:175], v[112:113], v[96:97] op_sel:[0,1,0] op_sel_hi:[1,1,1] neg_lo:[1,0,0] neg_hi:[1,0,0]
    v_pk_fma_f32 v[100:101], v[178:179], v[114:115], v[100:101] op_sel:[0,1,0] op_sel_hi:[1,1,1] neg_lo:[1,0,0] neg_hi:[1,0,0]
    v_pk_fma_f32 v[104:105], v[182:183], v[116:117], v[104:105] op_sel:[0,1,0] op_sel_hi:[1,1,1] neg_lo:[1,0,0] neg_hi:[1,0,0]
    v_pk_fma_f32 v[90:91], v[166:167], v[108:109], v[90:91] op_sel:[0,0,0] op_sel_hi:[1,0,1]
    v_pk_fma_f32 v[94:95], v[170:171], v[110:111], v[94:95] op_sel:[0,0,0] op_sel_hi:[1,0,1]
    v_pk_fma_f32 v[98:99], v[174:175], v[112:113], v[98:99] op_sel:[0,0,0] op_sel_hi:[1,0,1]
    v_pk_fma_f32 v[102:103], v[178:179], v[114:115], v[102:103] op_sel:[0,0,0] op_sel_hi:[1,0,1]
    v_pk_fma_f32 v[106:107], v[182:183], v[116:117], v[106:107] op_sel:[0,0,0] op_sel_hi:[1,0,1]
    v_pk_fma_f32 v[8:9], v[144:145], v[90:91], v[8:9] op_sel:[1,0,0] op_sel_hi:[1,1,1] neg_lo:[1,0,0] neg_hi:[1,0,0]
    v_pk_fma_f32 v[16:17], v[146:147], v[94:95], v[16:17] op_sel:[1,0,0] op_sel_hi:[1,1,1] neg_lo:[1,0,0] neg_hi:[1,0,0]
    v_pk_fma_f32 v[48:49], v[144:145], v[88:89], v[48:49] op_sel:[1,0,0] op_sel_hi:[1,1,1]
    v_pk_fma_f32 v[56:57], v[146:147], v[92:93], v[56:57] op_sel:[1,0,0] op_sel_hi:[1,1,1]
    v_pk_fma_f32 v[8:9], v[144:145], v[88:89], v[8:9] op_sel:[0,0,0] op_sel_hi:[0,1,1]
    v_pk_fma_f32 v[16:17], v[146:147], v[92:93], v[16:17] op_sel:[0,0,0] op_sel_hi:[0,1,1]
    v_pk_fma_f32 v[48:49], v[144:145], v[90:91], v[48:49] op_sel:[0,0,0] op_sel_hi:[0,1,1]
    v_pk_fma_f32 v[56:57], v[146:147], v[94:95], v[56:57] op_sel:[0,0,0] op_sel_hi:[0,1,1]
    v_pk_fma_f32 v[10:11], v[144:145], v[48:49], v[10:11] op_sel:[1,0,0] op_sel_hi:[1,1,1] neg_lo:[1,0,0] neg_hi:[1,0,0]
    v_pk_fma_f32 v[18:19], v[146:147], v[56:57], v[18:19] op_sel:[1,0,0] op_sel_hi:[1,1,1] neg_lo:[1,0,0] neg_hi:[1,0,0]
    v_pk_fma_f32 v[50:51], v[144:145], v[8:9], v[50:51] op_sel:[1,0,0] op_sel_hi:[1,1,1]
    v_pk_fma_f32 v[58:59], v[146:147], v[16:17], v[58:59] op_sel:[1,0,0] op_sel_hi:[1,1,1]
    v_pk_fma_f32 v[10:11], v[144:145], v[8:9], v[10:11] op_sel:[0,0,0] op_sel_hi:[0,1,1]
    v_pk_fma_f32 v[18:19], v[146:147], v[16:17], v[18:19] op_sel:[0,0,0] op_sel_hi:[0,1,1]
    v_pk_fma_f32 v[50:51], v[144:145], v[48:49], v[50:51] op_sel:[0,0,0] op_sel_hi:[0,1,1]
    v_pk_fma_f32 v[58:59], v[146:147], v[56:57], v[58:59] op_sel:[0,0,0] op_sel_hi:[0,1,1]
    v_pk_fma_f32 v[12:13], v[144:145], v[50:51], v[12:13] op_sel:[1,0,0] op_sel_hi:[1,1,1] neg_lo:[1,0,0] neg_hi:[1,0,0]
    v_pk_fma_f32 v[20:21], v[146:147], v[58:59], v[20:21] op_sel:[1,0,0] op_sel_hi:[1,1,1] neg_lo:[1,0,0] neg_hi:[1,0,0]
    v_pk_fma_f32 v[52:53], v[144:145], v[10:11], v[52:53] op_sel:[1,0,0] op_sel_hi:[1,1,1]
    v_pk_fma_f32 v[60:61], v[146:147], v[18:19], v[60:61] op_sel:[1,0,0] op_sel_hi:[1,1,1]
    v_pk_fma_f32 v[12:13], v[144:145], v[10:11], v[12:13] op_sel:[0,0,0] op_sel_hi:[0,1,1]
    v_pk_fma_f32 v[20:21], v[146:147], v[18:19], v[20:21] op_sel:[0,0,0] op_sel_hi:[0,1,1]
    v_pk_fma_f32 v[52:53], v[144:145], v[50:51], v[52:53] op_sel:[0,0,0] op_sel_hi:[0,1,1]
    v_pk_fma_f32 v[60:61], v[146:147], v[58:59], v[60:61] op_sel:[0,0,0] op_sel_hi:[0,1,1]
    v_pk_fma_f32 v[14:15], v[144:145], v[52:53], v[14:15] op_sel:[1,0,0] op_sel_hi:[1,1,1] neg_lo:[1,0,0] neg_hi:[1,0,0]
    v_pk_fma_f32 v[22:23], v[146:147], v[60:61], v[22:23] op_sel:[1,0,0] op_sel_hi:[1,1,1] neg_lo:[1,0,0] neg_hi:[1,0,0]
    v_pk_fma_f32 v[54:55], v[144:145], v[12:13], v[54:55] op_sel:[1,0,0] op_sel_hi:[1,1,1]
    v_pk_fma_f32 v[62:63], v[146:147], v[20:21], v[62:63] op_sel:[1,0,0] op_sel_hi:[1,1,1]
    v_pk_fma_f32 v[14:15], v[144:145], v[12:13], v[14:15] op_sel:[0,0,0] op_sel_hi:[0,1,1]
    v_pk_fma_f32 v[22:23], v[146:147], v[20:21], v[22:23] op_sel:[0,0,0] op_sel_hi:[0,1,1]
    v_pk_fma_f32 v[54:55], v[144:145], v[52:53], v[54:55] op_sel:[0,0,0] op_sel_hi:[0,1,1]
    v_pk_fma_f32 v[62:63], v[146:147], v[60:61], v[62:63] op_sel:[0,0,0] op_sel_hi:[0,1,1]
    v_cvt_pk_bf16_f32 v154, v8, v9
    v_cvt_pk_bf16_f32 v155, v10, v11
    v_cvt_pk_bf16_f32 v156, v12, v13
    v_cvt_pk_bf16_f32 v157, v14, v15
    v_cvt_pk_bf16_f32 v158, -v48, -v49
    v_cvt_pk_bf16_f32 v159, -v50, -v51
    v_cvt_pk_bf16_f32 v160, -v52, -v53
    v_cvt_pk_bf16_f32 v161, -v54, -v55
    v_mfma_f32_16x16x32_bf16 v[108:111], v[154:157], v[240:243], 0
    s_nop 0
    v_mfma_f32_16x16x32_bf16 v[112:115], v[158:161], v[240:243], 0
    v_mfma_f32_16x16x32_bf16 v[116:119], v[154:157], v[244:247], 0
    v_mfma_f32_16x16x32_bf16 v[120:123], v[158:161], v[244:247], 0
    v_cvt_pk_bf16_f32 v162, v16, v17
    v_cvt_pk_bf16_f32 v163, v18, v19
    v_cvt_pk_bf16_f32 v164, v20, v21
    v_cvt_pk_bf16_f32 v165, v22, v23
    v_cvt_pk_bf16_f32 v166, -v56, -v57
    v_cvt_pk_bf16_f32 v167, -v58, -v59
    v_cvt_pk_bf16_f32 v168, -v60, -v61
    v_cvt_pk_bf16_f32 v169, -v62, -v63
    v_mfma_f32_16x16x32_bf16 v[124:127], v[162:165], v[240:243], 0
    s_nop 0
    v_mfma_f32_16x16x32_bf16 v[128:131], v[166:169], v[240:243], 0
    v_mfma_f32_16x16x32_bf16 v[132:135], v[162:165], v[244:247], 0
    v_mfma_f32_16x16x32_bf16 v[136:139], v[166:169], v[244:247], 0
    v_cvt_pk_bf16_f32 v174, v108, v109
    v_cvt_pk_bf16_f32 v175, v110, v111
    v_cvt_pk_bf16_f32 v176, v112, v113
    v_cvt_pk_bf16_f32 v177, v114, v115
    buffer_store_dwordx4 v[174:177], v7, s[48:51], s91 offen offset:0 sc1
    v_cvt_pk_bf16_f32 v178, v116, v117
    v_cvt_pk_bf16_f32 v179, v118, v119
    v_cvt_pk_bf16_f32 v180, v120, v121
    v_cvt_pk_bf16_f32 v181, v122, v123
    buffer_store_dwordx4 v[178:181], v7, s[48:51], s91 offen offset:1024 sc1
    ds_read_b64_tr_b16 v[214:215], v249 offset:0
    ds_read_b64_tr_b16 v[216:217], v249 offset:2560
    ds_read_b64_tr_b16 v[218:219], v249 offset:32
    ds_read_b64_tr_b16 v[220:221], v249 offset:2592
    ds_read_b64_tr_b16 v[222:223], v249 offset:64
    ds_read_b64_tr_b16 v[224:225], v249 offset:2624
    ds_read_b64_tr_b16 v[226:227], v249 offset:96
    ds_read_b64_tr_b16 v[228:229], v249 offset:2656
    ds_read_b64_tr_b16 v[230:231], v249 offset:128
    ds_read_b64_tr_b16 v[232:233], v249 offset:2688
    v_pk_fma_f32 v[24:25], v[148:149], v[98:99], v[24:25] op_sel:[1,0,0] op_sel_hi:[1,1,1] neg_lo:[1,0,0] neg_hi:[1,0,0]
    v_pk_fma_f32 v[32:33], v[150:151], v[102:103], v[32:33] op_sel:[1,0,0] op_sel_hi:[1,1,1] neg_lo:[1,0,0] neg_hi:[1,0,0]
    v_pk_fma_f32 v[64:65], v[148:149], v[96:97], v[64:65] op_sel:[1,0,0] op_sel_hi:[1,1,1]
    v_pk_fma_f32 v[72:73], v[150:151], v[100:101], v[72:73] op_sel:[1,0,0] op_sel_hi:[1,1,1]
    v_pk_fma_f32 v[24:25], v[148:149], v[96:97], v[24:25] op_sel:[0,0,0] op_sel_hi:[0,1,1]
    v_pk_fma_f32 v[32:33], v[150:151], v[100:101], v[32:33] op_sel:[0,0,0] op_sel_hi:[0,1,1]
    v_pk_fma_f32 v[64:65], v[148:149], v[98:99], v[64:65] op_sel:[0,0,0] op_sel_hi:[0,1,1]
    v_pk_fma_f32 v[72:73], v[150:151], v[102:103], v[72:73] op_sel:[0,0,0] op_sel_hi:[0,1,1]
    v_pk_fma_f32 v[26:27], v[148:149], v[64:65], v[26:27] op_sel:[1,0,0] op_sel_hi:[1,1,1] neg_lo:[1,0,0] neg_hi:[1,0,0]
    v_pk_fma_f32 v[34:35], v[150:151], v[72:73], v[34:35] op_sel:[1,0,0] op_sel_hi:[1,1,1] neg_lo:[1,0,0] neg_hi:[1,0,0]
    v_pk_fma_f32 v[66:67], v[148:149], v[24:25], v[66:67] op_sel:[1,0,0] op_sel_hi:[1,1,1]
    v_pk_fma_f32 v[74:75], v[150:151], v[32:33], v[74:75] op_sel:[1,0,0] op_sel_hi:[1,1,1]
    v_pk_fma_f32 v[26:27], v[148:149], v[24:25], v[26:27] op_sel:[0,0,0] op_sel_hi:[0,1,1]
    v_pk_fma_f32 v[34:35], v[150:151], v[32:33], v[34:35] op_sel:[0,0,0] op_sel_hi:[0,1,1]
    v_pk_fma_f32 v[66:67], v[148:149], v[64:65], v[66:67] op_sel:[0,0,0] op_sel_hi:[0,1,1]
    v_pk_fma_f32 v[74:75], v[150:151], v[72:73], v[74:75] op_sel:[0,0,0] op_sel_hi:[0,1,1]
    v_pk_fma_f32 v[28:29], v[148:149], v[66:67], v[28:29] op_sel:[1,0,0] op_sel_hi:[1,1,1] neg_lo:[1,0,0] neg_hi:[1,0,0]
    v_pk_fma_f32 v[36:37], v[150:151], v[74:75], v[36:37] op_sel:[1,0,0] op_sel_hi:[1,1,1] neg_lo:[1,0,0] neg_hi:[1,0,0]
    v_pk_fma_f32 v[68:69], v[148:149], v[26:27], v[68:69] op_sel:[1,0,0] op_sel_hi:[1,1,1]
    v_pk_fma_f32 v[76:77], v[150:151], v[34:35], v[76:77] op_sel:[1,0,0] op_sel_hi:[1,1,1]
    v_pk_fma_f32 v[28:29], v[148:149], v[26:27], v[28:29] op_sel:[0,0,0] op_sel_hi:[0,1,1]
    v_pk_fma_f32 v[36:37], v[150:151], v[34:35], v[36:37] op_sel:[0,0,0] op_sel_hi:[0,1,1]
    v_pk_fma_f32 v[68:69], v[148:149], v[66:67], v[68:69] op_sel:[0,0,0] op_sel_hi:[0,1,1]
    v_pk_fma_f32 v[76:77], v[150:151], v[74:75], v[76:77] op_sel:[0,0,0] op_sel_hi:[0,1,1]
    v_pk_fma_f32 v[30:31], v[148:149], v[68:69], v[30:31] op_sel:[1,0,0] op_sel_hi:[1,1,1] neg_lo:[1,0,0] neg_hi:[1,0,0]
    v_pk_fma_f32 v[38:39], v[150:151], v[76:77], v[38:39] op_sel:[1,0,0] op_sel_hi:[1,1,1] neg_lo:[1,0,0] neg_hi:[1,0,0]
    v_pk_fma_f32 v[70:71], v[148:149], v[28:29], v[70:71] op_sel:[1,0,0] op_sel_hi:[1,1,1]
    v_pk_fma_f32 v[78:79], v[150:151], v[36:37], v[78:79] op_sel:[1,0,0] op_sel_hi:[1,1,1]
    v_pk_fma_f32 v[30:31], v[148:149], v[28:29], v[30:31] op_sel:[0,0,0] op_sel_hi:[0,1,1]
    v_pk_fma_f32 v[38:39], v[150:151], v[36:37], v[38:39] op_sel:[0,0,0] op_sel_hi:[0,1,1]
    v_pk_fma_f32 v[70:71], v[148:149], v[68:69], v[70:71] op_sel:[0,0,0] op_sel_hi:[0,1,1]
    v_pk_fma_f32 v[78:79], v[150:151], v[76:77], v[78:79] op_sel:[0,0,0] op_sel_hi:[0,1,1]
    v_cvt_pk_bf16_f32 v182, v124, v125
    v_cvt_pk_bf16_f32 v183, v126, v127
    v_cvt_pk_bf16_f32 v184, v128, v129
    v_cvt_pk_bf16_f32 v185, v130, v131
    buffer_store_dwordx4 v[182:185], v7, s[48:51], s91 offen offset:2048 sc1
    v_cvt_pk_bf16_f32 v186, v132, v133
    v_cvt_pk_bf16_f32 v187, v134, v135
    v_cvt_pk_bf16_f32 v188, v136, v137
    v_cvt_pk_bf16_f32 v189, v138, v139
    buffer_store_dwordx4 v[186:189], v7, s[48:51], s91 offen offset:3072 sc1
    s_add_u32 s91, s91, 4096
    v_cvt_pk_bf16_f32 v154, v24, v25
    v_cvt_pk_bf16_f32 v155, v26, v27
    v_cvt_pk_bf16_f32 v156, v28, v29
    v_cvt_pk_bf16_f32 v157, v30, v31
    v_cvt_pk_bf16_f32 v158, -v64, -v65
    v_cvt_pk_bf16_f32 v159, -v66, -v67
    v_cvt_pk_bf16_f32 v160, -v68, -v69
    v_cvt_pk_bf16_f32 v161, -v70, -v71
    v_mfma_f32_16x16x32_bf16 v[108:111], v[154:157], v[240:243], 0
    s_nop 0
    v_mfma_f32_16x16x32_bf16 v[112:115], v[158:161], v[240:243], 0
    v_mfma_f32_16x16x32_bf16 v[116:119], v[154:157], v[244:247], 0
    v_mfma_f32_16x16x32_bf16 v[120:123], v[158:161], v[244:247], 0
    v_cvt_pk_bf16_f32 v162, v32, v33
    v_cvt_pk_bf16_f32 v163, v34, v35
    v_cvt_pk_bf16_f32 v164, v36, v37
    v_cvt_pk_bf16_f32 v165, v38, v39
    v_cvt_pk_bf16_f32 v166, -v72, -v73
    v_cvt_pk_bf16_f32 v167, -v74, -v75
    v_cvt_pk_bf16_f32 v168, -v76, -v77
    v_cvt_pk_bf16_f32 v169, -v78, -v79
    v_mfma_f32_16x16x32_bf16 v[124:127], v[162:165], v[240:243], 0
    s_nop 0
    v_mfma_f32_16x16x32_bf16 v[128:131], v[166:169], v[240:243], 0
    v_mfma_f32_16x16x32_bf16 v[132:135], v[162:165], v[244:247], 0
    v_mfma_f32_16x16x32_bf16 v[136:139], v[166:169], v[244:247], 0
    v_pk_fma_f32 v[40:41], v[152:153], v[106:107], v[40:41] op_sel:[1,0,0] op_sel_hi:[1,1,1] neg_lo:[1,0,0] neg_hi:[1,0,0]
    v_pk_fma_f32 v[80:81], v[152:153], v[104:105], v[80:81] op_sel:[1,0,0] op_sel_hi:[1,1,1]
    v_pk_fma_f32 v[40:41], v[152:153], v[104:105], v[40:41] op_sel:[0,0,0] op_sel_hi:[0,1,1]
    v_pk_fma_f32 v[80:81], v[152:153], v[106:107], v[80:81] op_sel:[0,0,0] op_sel_hi:[0,1,1]
    v_pk_fma_f32 v[42:43], v[152:153], v[80:81], v[42:43] op_sel:[1,0,0] op_sel_hi:[1,1,1] neg_lo:[1,0,0] neg_hi:[1,0,0]
    v_pk_fma_f32 v[82:83], v[152:153], v[40:41], v[82:83] op_sel:[1,0,0] op_sel_hi:[1,1,1]
    v_pk_fma_f32 v[42:43], v[152:153], v[40:41], v[42:43] op_sel:[0,0,0] op_sel_hi:[0,1,1]
    v_pk_fma_f32 v[82:83], v[152:153], v[80:81], v[82:83] op_sel:[0,0,0] op_sel_hi:[0,1,1]
    v_pk_fma_f32 v[44:45], v[152:153], v[82:83], v[44:45] op_sel:[1,0,0] op_sel_hi:[1,1,1] neg_lo:[1,0,0] neg_hi:[1,0,0]
    v_pk_fma_f32 v[84:85], v[152:153], v[42:43], v[84:85] op_sel:[1,0,0] op_sel_hi:[1,1,1]
    v_pk_fma_f32 v[44:45], v[152:153], v[42:43], v[44:45] op_sel:[0,0,0] op_sel_hi:[0,1,1]
    v_pk_fma_f32 v[84:85], v[152:153], v[82:83], v[84:85] op_sel:[0,0,0] op_sel_hi:[0,1,1]
    v_pk_fma_f32 v[46:47], v[152:153], v[84:85], v[46:47] op_sel:[1,0,0] op_sel_hi:[1,1,1] neg_lo:[1,0,0] neg_hi:[1,0,0]
    v_pk_fma_f32 v[86:87], v[152:153], v[44:45], v[86:87] op_sel:[1,0,0] op_sel_hi:[1,1,1]
    v_pk_fma_f32 v[46:47], v[152:153], v[44:45], v[46:47] op_sel:[0,0,0] op_sel_hi:[0,1,1]
    v_pk_fma_f32 v[86:87], v[152:153], v[84:85], v[86:87] op_sel:[0,0,0] op_sel_hi:[0,1,1]
    v_cvt_pk_bf16_f32 v190, v108, v109
    v_cvt_pk_bf16_f32 v191, v110, v111
    v_cvt_pk_bf16_f32 v192, v112, v113
    v_cvt_pk_bf16_f32 v193, v114, v115
    buffer_store_dwordx4 v[190:193], v7, s[48:51], s91 offen offset:0 sc1
    v_cvt_pk_bf16_f32 v194, v116, v117
    v_cvt_pk_bf16_f32 v195, v118, v119
    v_cvt_pk_bf16_f32 v196, v120, v121
    v_cvt_pk_bf16_f32 v197, v122, v123
    buffer_store_dwordx4 v[194:197], v7, s[48:51], s91 offen offset:1024 sc1
    v_cvt_pk_bf16_f32 v154, v40, v41
    v_cvt_pk_bf16_f32 v155, v42, v43
    v_cvt_pk_bf16_f32 v156, v44, v45
    v_cvt_pk_bf16_f32 v157, v46, v47
    v_cvt_pk_bf16_f32 v158, -v80, -v81
    v_cvt_pk_bf16_f32 v159, -v82, -v83
    v_cvt_pk_bf16_f32 v160, -v84, -v85
    v_cvt_pk_bf16_f32 v161, -v86, -v87
    v_mfma_f32_16x16x32_bf16 v[108:111], v[154:157], v[240:243], 0
    s_nop 0
    v_mfma_f32_16x16x32_bf16 v[112:115], v[158:161], v[240:243], 0
    v_mfma_f32_16x16x32_bf16 v[116:119], v[154:157], v[244:247], 0
    v_mfma_f32_16x16x32_bf16 v[120:123], v[158:161], v[244:247], 0
    v_cvt_pk_bf16_f32 v198, v124, v125
    v_cvt_pk_bf16_f32 v199, v126, v127
    v_cvt_pk_bf16_f32 v200, v128, v129
    v_cvt_pk_bf16_f32 v201, v130, v131
    buffer_store_dwordx4 v[198:201], v7, s[48:51], s91 offen offset:2048 sc1
    v_cvt_pk_bf16_f32 v202, v132, v133
    v_cvt_pk_bf16_f32 v203, v134, v135
    v_cvt_pk_bf16_f32 v204, v136, v137
    v_cvt_pk_bf16_f32 v205, v138, v139
    buffer_store_dwordx4 v[202:205], v7, s[48:51], s91 offen offset:3072 sc1
    v_cvt_pk_bf16_f32 v206, v108, v109
    v_cvt_pk_bf16_f32 v207, v110, v111
    v_cvt_pk_bf16_f32 v208, v112, v113
    v_cvt_pk_bf16_f32 v209, v114, v115
    buffer_store_dwordx4 v[206:209], v7, s[48:51], s93 offen offset:0 sc1
    v_cvt_pk_bf16_f32 v210, v116, v117
    v_cvt_pk_bf16_f32 v211, v118, v119
    v_cvt_pk_bf16_f32 v212, v120, v121
    v_cvt_pk_bf16_f32 v213, v122, v123
    buffer_store_dwordx4 v[210:213], v7, s[48:51], s93 offen offset:1024 sc1
    s_waitcnt lgkmcnt(0)
    s_barrier
    s_mov_b32 s59, 0xffff0000
    s_waitcnt lgkmcnt(0)
    v_lshlrev_b32 v96, 16, v214
    v_and_b32 v97, s59, v214
    v_lshlrev_b32 v98, 16, v215
    v_and_b32 v99, s59, v215
    v_pk_mul_f32 v[96:97], v[96:97], v[234:235] op_sel:[0,0] op_sel_hi:[1,0]
    v_pk_mul_f32 v[98:99], v[98:99], v[234:235] op_sel:[0,0] op_sel_hi:[1,0]
    v_lshlrev_b32 v100, 16, v216
    v_and_b32 v101, s59, v216
    v_lshlrev_b32 v102, 16, v217
    v_and_b32 v103, s59, v217
    v_pk_mul_f32 v[100:101], v[100:101], v[234:235] op_sel:[0,0] op_sel_hi:[1,0]
    v_pk_mul_f32 v[102:103], v[102:103], v[234:235] op_sel:[0,0] op_sel_hi:[1,0]
    v_lshlrev_b32 v104, 16, v218
    v_and_b32 v105, s59, v218
    v_lshlrev_b32 v106, 16, v219
    v_and_b32 v107, s59, v219
    v_pk_mul_f32 v[104:105], v[104:105], v[234:235] op_sel:[0,1] op_sel_hi:[1,1]
    v_pk_mul_f32 v[106:107], v[106:107], v[234:235] op_sel:[0,1] op_sel_hi:[1,1]
    v_lshlrev_b32 v108, 16, v220
    v_and_b32 v109, s59, v220
    v_lshlrev_b32 v110, 16, v221
    v_and_b32 v111, s59, v221
    v_pk_mul_f32 v[108:109], v[108:109], v[234:235] op_sel:[0,1] op_sel_hi:[1,1]
    v_pk_mul_f32 v[110:111], v[110:111], v[234:235] op_sel:[0,1] op_sel_hi:[1,1]
    v_lshlrev_b32 v112, 16, v222
    v_and_b32 v113, s59, v222
    v_lshlrev_b32 v114, 16, v223
    v_and_b32 v115, s59, v223
    v_pk_mul_f32 v[112:113], v[112:113], v[236:237] op_sel:[0,0] op_sel_hi:[1,0]
    v_pk_mul_f32 v[114:115], v[114:115], v[236:237] op_sel:[0,0] op_sel_hi:[1,0]
    v_lshlrev_b32 v116, 16, v224
    v_and_b32 v117, s59, v224
    v_lshlrev_b32 v118, 16, v225
    v_and_b32 v119, s59, v225
    v_pk_mul_f32 v[116:117], v[116:117], v[236:237] op_sel:[0,0] op_sel_hi:[1,0]
    v_pk_mul_f32 v[118:119], v[118:119], v[236:237] op_sel:[0,0] op_sel_hi:[1,0]
    v_lshlrev_b32 v120, 16, v226
    v_and_b32 v121, s59, v226
    v_lshlrev_b32 v122, 16, v227
    v_and_b32 v123, s59, v227
    v_pk_mul_f32 v[120:121], v[120:121], v[236:237] op_sel:[0,1] op_sel_hi:[1,1]
    v_pk_mul_f32 v[122:123], v[122:123], v[236:237] op_sel:[0,1] op_sel_hi:[1,1]
    v_lshlrev_b32 v124, 16, v228
    v_and_b32 v125, s59, v228
    v_lshlrev_b32 v126, 16, v229
    v_and_b32 v127, s59, v229
    v_pk_mul_f32 v[124:125], v[124:125], v[236:237] op_sel:[0,1] op_sel_hi:[1,1]
    v_pk_mul_f32 v[126:127], v[126:127], v[236:237] op_sel:[0,1] op_sel_hi:[1,1]
    v_lshlrev_b32 v128, 16, v230
    v_and_b32 v129, s59, v230
    v_lshlrev_b32 v130, 16, v231
    v_and_b32 v131, s59, v231
    v_pk_mul_f32 v[128:129], v[128:129], v[238:239] op_sel:[0,0] op_sel_hi:[1,0]
    v_pk_mul_f32 v[130:131], v[130:131], v[238:239] op_sel:[0,0] op_sel_hi:[1,0]
    v_lshlrev_b32 v132, 16, v232
    v_and_b32 v133, s59, v232
    v_lshlrev_b32 v134, 16, v233
    v_and_b32 v135, s59, v233
    v_pk_mul_f32 v[132:133], v[132:133], v[238:239] op_sel:[0,0] op_sel_hi:[1,0]
    v_pk_mul_f32 v[134:135], v[134:135], v[238:239] op_sel:[0,0] op_sel_hi:[1,0]
    v_and_b32 v253, 15, v0
    v_lshrrev_b32 v254, 5, v0
    v_lshrrev_b32 v1, 1, v253
    v_xor_b32 v1, v1, v254
    v_lshlrev_b32 v1, 4, v1
    v_lshl_add_u32 v1, v253, 7, v1
    v_bfe_u32 v254, v0, 4, 1
    v_lshl_add_u32 v1, v254, 3, v1
    v_add_u32 v1, 143360, v1
    v_xor_b32 v2, 32, v1
    v_xor_b32 v3, 64, v1
    v_xor_b32 v4, 96, v1
    s_mov_b32 s44, s28
    s_mov_b32 s45, s29
    s_mov_b32 s46, 10485760
    s_mov_b32 s47, 0x20000
    v_lshrrev_b32 v253, 4, v0
    v_mul_u32_u24 v253, 20480, v253
    v_and_b32 v254, 15, v0
    v_lshl_add_u32 v253, v254, 2, v253
    s_lshl_b32 s59, s52, 2
    s_add_u32 s59, s59, s55
    s_mul_i32 s59, s59, 163840
    s_mul_i32 s60, s53, 320
    s_add_u32 s59, s59, s60
    s_add_u32 s59, s59, 2560
    v_add_u32 v140, s59, v253
    s_mov_b32 s94, 0
    s_mov_b32 s95, 5120
    s_mov_b32 s96, 10240
    s_mov_b32 s97, 15360
    s_mov_b32 s98, 81920
    s_mov_b32 s99, 87040
    s_mov_b32 s100, 92160
    s_mov_b32 s101, 97280
    s_mov_b64 exec, 0xff
    s_mov_b32 s66, 0
    s_branch L_xc_53
L_xp_52:
    buffer_load_dword v251, v250, s[48:51], s67 offen sc1
L_xc_53:
    s_waitcnt vmcnt(0)
    v_xor_b32 v251, s56, v251
    v_cmp_le_u32 vcc, 16, v251
    s_cbranch_vccz L_xok_54
    s_add_u32 s66, s66, 1
    s_cmp_lt_u32 s66, 200000
    s_cbranch_scc1 L_xp_52
L_xok_54:
    v_cmp_ne_u32 vcc, s76, v251
    s_nop 0
    s_cmp_eq_u64 vcc, 0
    s_cselect_b32 s67, 1, 0
    s_mov_b64 exec, -1
    s_lshl_b32 s63, s35, 4
    s_add_u32 s63, s63, s52
    s_lshl_b32 s63, s63, 10
    s_add_u32 s63, s63, 4096
    s_lshl_b32 s64, s55, 7
    s_add_u32 s63, s63, s64
    s_lshl_b32 s64, s53, 2
    s_add_u32 s64, s64, s63
    v_mov_b32 v250, s56
    v_mov_b32 v251, 0
    v_lshlrev_b32 v252, 2, v0
    s_mov_b32 s66, 0
    s_waitcnt vmcnt(0)
    s_mov_b64 exec, 1
    s_cmp_eq_u32 s67, 0
    s_cbranch_scc1 L_slow_55
    buffer_store_dword v250, v251, s[48:51], s64 offen
    s_branch L_go_56
L_slow_55:
    buffer_store_dword v250, v251, s[48:51], s64 offen sc1
L_go_56:
    s_mov_b64 exec, 0xff
    s_mov_b64 exec, -1
    s_barrier
L_BP2:
    ds_read_b64 v[56:57], v1 offset:0
    ds_read_b64 v[58:59], v1 offset:10240
    ds_read_b64 v[60:61], v1 offset:2048
    ds_read_b64 v[62:63], v1 offset:12288
    ds_read_b64 v[64:65], v1 offset:4096
    ds_read_b64 v[66:67], v1 offset:14336
    ds_read_b64 v[68:69], v1 offset:6144
    ds_read_b64 v[70:71], v1 offset:16384
    ds_read_b64 v[72:73], v1 offset:8192
    ds_read_b64 v[74:75], v1 offset:18432
    ds_read_b64 v[76:77], v2 offset:0
    ds_read_b64 v[78:79], v2 offset:10240
    ds_read_b64 v[80:81], v2 offset:2048
    ds_read_b64 v[82:83], v2 offset:12288
    s_mov_b32 s65, 0
    s_mov_b32 s68, 0xffffb000
    v_add_u32 v6, 4096, v7
    s_movk_i32 s57, 8192
    s_add_u32 s61, s92, 81920
    s_mov_b32 s58, s92
    s_sub_u32 s59, s92, 8192
    s_add_u32 s60, s92, 73728
    s_bitcmp1_b32 s54, 0
    s_cselect_b32 s57, 0xffffe000, s57
    s_cselect_b32 s61, s59, s61
    s_cselect_b32 s58, s60, s58
    s_sub_u32 s62, s91, 4096
    s_add_u32 s62, s62, s57
    s_cmp_eq_u32 s62, s61
    s_cselect_b32 s62, s58, s62
    s_xor_b32 s59, s53, s54
    s_bitcmp1_b32 s59, 0
    s_cselect_b32 s70, 0, s57
    s_add_u32 s62, s62, s70
    s_cmp_eq_u32 s62, s61
    s_cselect_b32 s62, s58, s62
    s_waitcnt lgkmcnt(10)
    v_mfma_f32_16x16x32_bf16 v[96:99], v[174:177], v[56:59], v[96:99]
    v_mfma_f32_16x16x32_bf16 v[100:103], v[178:181], v[56:59], v[100:103]
    ds_read_b64 v[84:85], v2 offset:4096
    ds_read_b64 v[86:87], v2 offset:14336
    v_mfma_f32_16x16x32_bf16 v[104:107], v[174:177], v[60:63], v[104:107]
    ds_read_b64 v[88:89], v2 offset:6144
    v_mfma_f32_16x16x32_bf16 v[108:111], v[178:181], v[60:63], v[108:111]
    ds_read_b64 v[90:91], v2 offset:16384
    s_waitcnt lgkmcnt(10)
    v_mfma_f32_16x16x32_bf16 v[112:115], v[174:177], v[64:67], v[112:115]
    v_mfma_f32_16x16x32_bf16 v[116:119], v[178:181], v[64:67], v[116:119]
    ds_read_b64 v[92:93], v2 offset:8192
    ds_read_b64 v[94:95], v2 offset:18432
    v_mfma_f32_16x16x32_bf16 v[120:123], v[174:177], v[68:71], v[120:123]
    ds_read_b64 v[56:57], v3 offset:0
    v_mfma_f32_16x16x32_bf16 v[124:127], v[178:181], v[68:71], v[124:127]
    ds_read_b64 v[58:59], v3 offset:10240
    s_waitcnt lgkmcnt(10)
    v_mfma_f32_16x16x32_bf16 v[128:131], v[174:177], v[72:75], v[128:131]
    ds_read_b64 v[60:61], v3 offset:2048
    v_mfma_f32_16x16x32_bf16 v[132:135], v[178:181], v[72:75], v[132:135]
    ds_read_b64 v[62:63], v3 offset:12288
    v_add_u32 v1, 0xffffb000, v1
    v_mfma_f32_16x16x32_bf16 v[96:99], v[182:185], v[76:79], v[96:99]
    ds_read_b64 v[64:65], v3 offset:4096
    ds_read_b64 v[66:67], v3 offset:14336
    v_mfma_f32_16x16x32_bf16 v[100:103], v[186:189], v[76:79], v[100:103]
    v_add_u32 v2, 0xffffb000, v2
    s_waitcnt lgkmcnt(10)
    v_mfma_f32_16x16x32_bf16 v[104:107], v[182:185], v[80:83], v[104:107]
    v_mfma_f32_16x16x32_bf16 v[108:111], v[186:189], v[80:83], v[108:111]
    ds_read_b64 v[68:69], v3 offset:6144
    ds_read_b64 v[70:71], v3 offset:16384
    v_mfma_f32_16x16x32_bf16 v[112:115], v[182:185], v[84:87], v[112:115]
    ds_read_b64 v[72:73], v3 offset:8192
    v_mfma_f32_16x16x32_bf16 v[116:119], v[186:189], v[84:87], v[116:119]
    ds_read_b64 v[74:75], v3 offset:18432
    s_waitcnt lgkmcnt(10)
    v_mfma_f32_16x16x32_bf16 v[120:123], v[182:185], v[88:91], v[120:123]
    v_mfma_f32_16x16x32_bf16 v[124:127], v[186:189], v[88:91], v[124:127]
    ds_read_b64 v[76:77], v4 offset:0
    ds_read_b64 v[78:79], v4 offset:10240
    v_mfma_f32_16x16x32_bf16 v[128:131], v[182:185], v[92:95], v[128:131]
    ds_read_b64 v[80:81], v4 offset:2048
    v_mfma_f32_16x16x32_bf16 v[132:135], v[186:189], v[92:95], v[132:135]
    ds_read_b64 v[82:83], v4 offset:12288
    s_mov_b64 exec, 0xff
L_fp_57:
    buffer_load_dword v251, v252, s[48:51], s63 offen sc1
    s_waitcnt vmcnt(0)
    v_cmp_ne_u32 vcc, s56, v251
    s_cbranch_vccz L_fok_58
    s_add_u32 s66, s66, 1
    s_cmp_lt_u32 s66, 200000
    s_cbranch_scc1 L_fp_57
L_fok_58:
    s_mov_b64 exec, -1
    buffer_load_dwordx4 v[8:11], v7, s[48:51], s62 offen offset:0 sc1
    buffer_load_dwordx4 v[12:15], v7, s[48:51], s62 offen offset:1024 sc1
    buffer_load_dwordx4 v[16:19], v7, s[48:51], s62 offen offset:2048 sc1
    buffer_load_dwordx4 v[20:23], v7, s[48:51], s62 offen offset:3072 sc1
    s_waitcnt lgkmcnt(10)
    v_mfma_f32_16x16x32_bf16 v[96:99], v[190:193], v[56:59], v[96:99]
    ds_read_b64 v[84:85], v4 offset:4096
    ds_read_b64 v[86:87], v4 offset:14336
    v_mfma_f32_16x16x32_bf16 v[100:103], v[194:197], v[56:59], v[100:103]
    buffer_load_dwordx4 v[24:27], v6, s[48:51], s62 offen offset:0 sc1
    v_add_u32 v3, 0xffffb000, v3
    v_mfma_f32_16x16x32_bf16 v[104:107], v[190:193], v[60:63], v[104:107]
    ds_read_b64 v[88:89], v4 offset:6144
    ds_read_b64 v[90:91], v4 offset:16384
    v_mfma_f32_16x16x32_bf16 v[108:111], v[194:197], v[60:63], v[108:111]
    buffer_load_dwordx4 v[28:31], v6, s[48:51], s62 offen offset:1024 sc1
    s_waitcnt lgkmcnt(10)
    v_mfma_f32_16x16x32_bf16 v[112:115], v[190:193], v[64:67], v[112:115]
    v_mfma_f32_16x16x32_bf16 v[116:119], v[194:197], v[64:67], v[116:119]
    ds_read_b64 v[92:93], v4 offset:8192
    ds_read_b64 v[94:95], v4 offset:18432
    v_mfma_f32_16x16x32_bf16 v[120:123], v[190:193], v[68:71], v[120:123]
    ds_read_b64 v[56:57], v1 offset:0
    ds_read_b64 v[58:59], v1 offset:10240
    v_mfma_f32_16x16x32_bf16 v[124:127], v[194:197], v[68:71], v[124:127]
    buffer_load_dwordx4 v[32:35], v6, s[48:51], s62 offen offset:2048 sc1
    s_waitcnt lgkmcnt(10)
    v_mfma_f32_16x16x32_bf16 v[128:131], v[190:193], v[72:75], v[128:131]
    ds_read_b64 v[60:61], v1 offset:2048
    ds_read_b64 v[62:63], v1 offset:12288
    v_mfma_f32_16x16x32_bf16 v[132:135], v[194:197], v[72:75], v[132:135]
    buffer_load_dwordx4 v[36:39], v6, s[48:51], s62 offen offset:3072 sc1
    ds_read_b64 v[64:65], v1 offset:4096
    v_mfma_f32_16x16x32_bf16 v[96:99], v[198:201], v[76:79], v[96:99]
    ds_read_b64 v[66:67], v1 offset:14336
    v_add_u32 v4, 0xffffb000, v4
    v_mfma_f32_16x16x32_bf16 v[100:103], v[202:205], v[76:79], v[100:103]
    s_waitcnt lgkmcnt(10)
    ds_read_b64 v[68:69], v1 offset:6144
    v_mfma_f32_16x16x32_bf16 v[104:107], v[198:201], v[80:83], v[104:107]
    ds_read_b64 v[70:71], v1 offset:16384
    s_add_u32 s62, s62, s57
    v_mfma_f32_16x16x32_bf16 v[108:111], v[202:205], v[80:83], v[108:111]
    s_cmp_eq_u32 s62, s61
    s_cselect_b32 s62, s58, s62
    v_mfma_f32_16x16x32_bf16 v[112:115], v[198:201], v[84:87], v[112:115]
    ds_read_b64 v[72:73], v1 offset:8192
    ds_read_b64 v[74:75], v1 offset:18432
    v_mfma_f32_16x16x32_bf16 v[116:119], v[202:205], v[84:87], v[116:119]
    buffer_load_dwordx4 v[40:43], v7, s[48:51], s62 offen offset:0 sc1
    s_waitcnt lgkmcnt(10)
    v_mfma_f32_16x16x32_bf16 v[120:123], v[198:201], v[88:91], v[120:123]
    v_mfma_f32_16x16x32_bf16 v[124:127], v[202:205], v[88:91], v[124:127]
    ds_read_b64 v[76:77], v2 offset:0
    ds_read_b64 v[78:79], v2 offset:10240
    v_mfma_f32_16x16x32_bf16 v[128:131], v[198:201], v[92:95], v[128:131]
    buffer_load_dwordx4 v[44:47], v7, s[48:51], s62 offen offset:1024 sc1
    ds_read_b64 v[80:81], v2 offset:2048
    v_mfma_f32_16x16x32_bf16 v[132:135], v[202:205], v[92:95], v[132:135]
    ds_read_b64 v[82:83], v2 offset:12288
    .p2align 3
L_bp2_60:
    s_waitcnt vmcnt(8)
    s_waitcnt lgkmcnt(10)
    v_mfma_f32_16x16x32_bf16 v[96:99], v[8:11], v[56:59], v[96:99]
    v_mfma_f32_16x16x32_bf16 v[100:103], v[12:15], v[56:59], v[100:103]
    ds_read_b64 v[84:85], v2 offset:4096
    ds_read_b64 v[86:87], v2 offset:14336
    v_mfma_f32_16x16x32_bf16 v[104:107], v[8:11], v[60:63], v[104:107]
    ds_read_b64 v[88:89], v2 offset:6144
    ds_read_b64 v[90:91], v2 offset:16384
    v_mfma_f32_16x16x32_bf16 v[108:111], v[12:15], v[60:63], v[108:111]
    buffer_load_dwordx4 v[48:51], v7, s[48:51], s62 offen offset:2048 sc1
    s_waitcnt lgkmcnt(10)
    v_mfma_f32_16x16x32_bf16 v[112:115], v[8:11], v[64:67], v[112:115]
    v_mfma_f32_16x16x32_bf16 v[116:119], v[12:15], v[64:67], v[116:119]
    ds_read_b64 v[92:93], v2 offset:8192
    ds_read_b64 v[94:95], v2 offset:18432
    v_mfma_f32_16x16x32_bf16 v[120:123], v[8:11], v[68:71], v[120:123]
    ds_read_b64 v[56:57], v3 offset:0
    ds_read_b64 v[58:59], v3 offset:10240
    v_mfma_f32_16x16x32_bf16 v[124:127], v[12:15], v[68:71], v[124:127]
    buffer_load_dwordx4 v[52:55], v7, s[48:51], s62 offen offset:3072 sc1
    s_waitcnt lgkmcnt(10)
    v_mfma_f32_16x16x32_bf16 v[128:131], v[8:11], v[72:75], v[128:131]
    ds_read_b64 v[60:61], v3 offset:2048
    ds_read_b64 v[62:63], v3 offset:12288
    v_mfma_f32_16x16x32_bf16 v[132:135], v[12:15], v[72:75], v[132:135]
    v_add_u32 v1, 0xffffb000, v1
    s_waitcnt vmcnt(8)
    v_mfma_f32_16x16x32_bf16 v[96:99], v[16:19], v[76:79], v[96:99]
    ds_read_b64 v[64:65], v3 offset:4096
    ds_read_b64 v[66:67], v3 offset:14336
    v_mfma_f32_16x16x32_bf16 v[100:103], v[20:23], v[76:79], v[100:103]
    v_add_u32 v2, 0xffffb000, v2
    s_waitcnt lgkmcnt(10)
    v_mfma_f32_16x16x32_bf16 v[104:107], v[16:19], v[80:83], v[104:107]
    v_mfma_f32_16x16x32_bf16 v[108:111], v[20:23], v[80:83], v[108:111]
    ds_read_b64 v[68:69], v3 offset:6144
    ds_read_b64 v[70:71], v3 offset:16384
    v_mfma_f32_16x16x32_bf16 v[112:115], v[16:19], v[84:87], v[112:115]
    buffer_load_dwordx4 v[8:11], v6, s[48:51], s62 offen offset:0 sc1
    ds_read_b64 v[72:73], v3 offset:8192
    v_mfma_f32_16x16x32_bf16 v[116:119], v[20:23], v[84:87], v[116:119]
    ds_read_b64 v[74:75], v3 offset:18432
    s_waitcnt lgkmcnt(10)
    v_mfma_f32_16x16x32_bf16 v[120:123], v[16:19], v[88:91], v[120:123]
    ds_read_b64 v[76:77], v4 offset:0
    v_mfma_f32_16x16x32_bf16 v[124:127], v[20:23], v[88:91], v[124:127]
    ds_read_b64 v[78:79], v4 offset:10240
    buffer_load_dwordx4 v[12:15], v6, s[48:51], s62 offen offset:1024 sc1
    v_mfma_f32_16x16x32_bf16 v[128:131], v[16:19], v[92:95], v[128:131]
    ds_read_b64 v[80:81], v4 offset:2048
    ds_read_b64 v[82:83], v4 offset:12288
    v_mfma_f32_16x16x32_bf16 v[132:135], v[20:23], v[92:95], v[132:135]
    s_waitcnt vmcnt(8)
    s_waitcnt lgkmcnt(10)
    v_mfma_f32_16x16x32_bf16 v[96:99], v[24:27], v[56:59], v[96:99]
    ds_read_b64 v[84:85], v4 offset:4096
    v_mfma_f32_16x16x32_bf16 v[100:103], v[28:31], v[56:59], v[100:103]
    ds_read_b64 v[86:87], v4 offset:14336
    v_add_u32 v3, 0xffffb000, v3
    v_mfma_f32_16x16x32_bf16 v[104:107], v[24:27], v[60:63], v[104:107]
    ds_read_b64 v[88:89], v4 offset:6144
    ds_read_b64 v[90:91], v4 offset:16384
    v_mfma_f32_16x16x32_bf16 v[108:111], v[28:31], v[60:63], v[108:111]
    buffer_load_dwordx4 v[16:19], v6, s[48:51], s62 offen offset:2048 sc1
    s_waitcnt lgkmcnt(10)
    v_mfma_f32_16x16x32_bf16 v[112:115], v[24:27], v[64:67], v[112:115]
    ds_read_b64 v[92:93], v4 offset:8192
    ds_read_b64 v[94:95], v4 offset:18432
    v_mfma_f32_16x16x32_bf16 v[116:119], v[28:31], v[64:67], v[116:119]
    ds_read_b64 v[56:57], v1 offset:0
    ds_read_b64 v[58:59], v1 offset:10240
    v_mfma_f32_16x16x32_bf16 v[120:123], v[24:27], v[68:71], v[120:123]
    buffer_load_dwordx4 v[20:23], v6, s[48:51], s62 offen offset:3072 sc1
    s_waitcnt lgkmcnt(10)
    v_mfma_f32_16x16x32_bf16 v[124:127], v[28:31], v[68:71], v[124:127]
    ds_read_b64 v[60:61], v1 offset:2048
    ds_read_b64 v[62:63], v1 offset:12288
    v_mfma_f32_16x16x32_bf16 v[128:131], v[24:27], v[72:75], v[128:131]
    s_add_u32 s62, s62, s57
    s_cmp_eq_u32 s62, s61
    v_mfma_f32_16x16x32_bf16 v[132:135], v[28:31], v[72:75], v[132:135]
    s_waitcnt vmcnt(8)
    ds_read_b64 v[64:65], v1 offset:4096
    v_mfma_f32_16x16x32_bf16 v[96:99], v[32:35], v[76:79], v[96:99]
    ds_read_b64 v[66:67], v1 offset:14336
    v_add_u32 v4, 0xffffb000, v4
    v_mfma_f32_16x16x32_bf16 v[100:103], v[36:39], v[76:79], v[100:103]
    s_cselect_b32 s62, s58, s62
    s_waitcnt lgkmcnt(10)
    v_mfma_f32_16x16x32_bf16 v[104:107], v[32:35], v[80:83], v[104:107]
    v_mfma_f32_16x16x32_bf16 v[108:111], v[36:39], v[80:83], v[108:111]
    ds_read_b64 v[68:69], v1 offset:6144
    ds_read_b64 v[70:71], v1 offset:16384
    v_mfma_f32_16x16x32_bf16 v[112:115], v[32:35], v[84:87], v[112:115]
    buffer_load_dwordx4 v[24:27], v7, s[48:51], s62 offen offset:0 sc1
    ds_read_b64 v[72:73], v1 offset:8192
    v_mfma_f32_16x16x32_bf16 v[116:119], v[36:39], v[84:87], v[116:119]
    ds_read_b64 v[74:75], v1 offset:18432
    s_waitcnt lgkmcnt(10)
    v_mfma_f32_16x16x32_bf16 v[120:123], v[32:35], v[88:91], v[120:123]
    ds_read_b64 v[76:77], v2 offset:0
    v_mfma_f32_16x16x32_bf16 v[124:127], v[36:39], v[88:91], v[124:127]
    ds_read_b64 v[78:79], v2 offset:10240
    buffer_load_dwordx4 v[28:31], v7, s[48:51], s62 offen offset:1024 sc1
    v_mfma_f32_16x16x32_bf16 v[128:131], v[32:35], v[92:95], v[128:131]
    ds_read_b64 v[80:81], v2 offset:2048
    ds_read_b64 v[82:83], v2 offset:12288
    v_mfma_f32_16x16x32_bf16 v[132:135], v[36:39], v[92:95], v[132:135]
    s_waitcnt vmcnt(8)
    s_waitcnt lgkmcnt(10)
    v_mfma_f32_16x16x32_bf16 v[96:99], v[40:43], v[56:59], v[96:99]
    v_mfma_f32_16x16x32_bf16 v[100:103], v[44:47], v[56:59], v[100:103]
    ds_read_b64 v[84:85], v2 offset:4096
    ds_read_b64 v[86:87], v2 offset:14336
    v_mfma_f32_16x16x32_bf16 v[104:107], v[40:43], v[60:63], v[104:107]
    ds_read_b64 v[88:89], v2 offset:6144
    ds_read_b64 v[90:91], v2 offset:16384
    v_mfma_f32_16x16x32_bf16 v[108:111], v[44:47], v[60:63], v[108:111]
    buffer_load_dwordx4 v[32:35], v7, s[48:51], s62 offen offset:2048 sc1
    s_waitcnt lgkmcnt(10)
    v_mfma_f32_16x16x32_bf16 v[112:115], v[40:43], v[64:67], v[112:115]
    ds_read_b64 v[92:93], v2 offset:8192
    v_mfma_f32_16x16x32_bf16 v[116:119], v[44:47], v[64:67], v[116:119]
    ds_read_b64 v[94:95], v2 offset:18432
    ds_read_b64 v[56:57], v3 offset:0
    v_mfma_f32_16x16x32_bf16 v[120:123], v[40:43], v[68:71], v[120:123]
    ds_read_b64 v[58:59], v3 offset:10240
    buffer_load_dwordx4 v[36:39], v7, s[48:51], s62 offen offset:3072 sc1
    v_mfma_f32_16x16x32_bf16 v[124:127], v[44:47], v[68:71], v[124:127]
    s_waitcnt lgkmcnt(10)
    ds_read_b64 v[60:61], v3 offset:2048
    v_mfma_f32_16x16x32_bf16 v[128:131], v[40:43], v[72:75], v[128:131]
    ds_read_b64 v[62:63], v3 offset:12288
    v_add_u32 v1, 0xffffb000, v1
    v_mfma_f32_16x16x32_bf16 v[132:135], v[44:47], v[72:75], v[132:135]
    s_waitcnt vmcnt(8)
    ds_read_b64 v[64:65], v3 offset:4096
    v_mfma_f32_16x16x32_bf16 v[96:99], v[48:51], v[76:79], v[96:99]
    ds_read_b64 v[66:67], v3 offset:14336
    v_add_u32 v2, 0xffffb000, v2
    v_mfma_f32_16x16x32_bf16 v[100:103], v[52:55], v[76:79], v[100:103]
    s_barrier
    s_waitcnt lgkmcnt(10)
    v_mfma_f32_16x16x32_bf16 v[104:107], v[48:51], v[80:83], v[104:107]
    v_mfma_f32_16x16x32_bf16 v[108:111], v[52:55], v[80:83], v[108:111]
    ds_read_b64 v[68:69], v3 offset:6144
    ds_read_b64 v[70:71], v3 offset:16384
    v_mfma_f32_16x16x32_bf16 v[112:115], v[48:51], v[84:87], v[112:115]
    buffer_load_dwordx4 v[40:43], v6, s[48:51], s62 offen offset:0 sc1
    ds_read_b64 v[72:73], v3 offset:8192
    v_mfma_f32_16x16x32_bf16 v[116:119], v[52:55], v[84:87], v[116:119]
    ds_read_b64 v[74:75], v3 offset:18432
    s_waitcnt lgkmcnt(10)
    v_mfma_f32_16x16x32_bf16 v[120:123], v[48:51], v[88:91], v[120:123]
    ds_read_b64 v[76:77], v4 offset:0
    v_mfma_f32_16x16x32_bf16 v[124:127], v[52:55], v[88:91], v[124:127]
    ds_read_b64 v[78:79], v4 offset:10240
    buffer_load_dwordx4 v[44:47], v6, s[48:51], s62 offen offset:1024 sc1
    v_mfma_f32_16x16x32_bf16 v[128:131], v[48:51], v[92:95], v[128:131]
    ds_read_b64 v[80:81], v4 offset:2048
    ds_read_b64 v[82:83], v4 offset:12288
    v_mfma_f32_16x16x32_bf16 v[132:135], v[52:55], v[92:95], v[132:135]
    s_waitcnt vmcnt(8)
    s_waitcnt lgkmcnt(10)
    v_mfma_f32_16x16x32_bf16 v[96:99], v[8:11], v[56:59], v[96:99]
    ds_read_b64 v[84:85], v4 offset:4096
    v_mfma_f32_16x16x32_bf16 v[100:103], v[12:15], v[56:59], v[100:103]
    ds_read_b64 v[86:87], v4 offset:14336
    v_add_u32 v3, 0xffffb000, v3
    v_mfma_f32_16x16x32_bf16 v[104:107], v[8:11], v[60:63], v[104:107]
    ds_read_b64 v[88:89], v4 offset:6144
    ds_read_b64 v[90:91], v4 offset:16384
    v_mfma_f32_16x16x32_bf16 v[108:111], v[12:15], v[60:63], v[108:111]
    buffer_load_dwordx4 v[48:51], v6, s[48:51], s62 offen offset:2048 sc1
    s_waitcnt lgkmcnt(10)
    v_mfma_f32_16x16x32_bf16 v[112:115], v[8:11], v[64:67], v[112:115]
    ds_read_b64 v[92:93], v4 offset:8192
    ds_read_b64 v[94:95], v4 offset:18432
    v_mfma_f32_16x16x32_bf16 v[116:119], v[12:15], v[64:67], v[116:119]
    ds_read_b64 v[56:57], v1 offset:0
    ds_read_b64 v[58:59], v1 offset:10240
    v_mfma_f32_16x16x32_bf16 v[120:123], v[8:11], v[68:71], v[120:123]
    buffer_load_dwordx4 v[52:55], v6, s[48:51], s62 offen offset:3072 sc1
    s_waitcnt lgkmcnt(10)
    v_mfma_f32_16x16x32_bf16 v[124:127], v[12:15], v[68:71], v[124:127]
    ds_read_b64 v[60:61], v1 offset:2048
    ds_read_b64 v[62:63], v1 offset:12288
    v_mfma_f32_16x16x32_bf16 v[128:131], v[8:11], v[72:75], v[128:131]
    s_add_u32 s62, s62, s57
    s_cmp_eq_u32 s62, s61
    v_mfma_f32_16x16x32_bf16 v[132:135], v[12:15], v[72:75], v[132:135]
    s_waitcnt vmcnt(8)
    ds_read_b64 v[64:65], v1 offset:4096
    v_mfma_f32_16x16x32_bf16 v[96:99], v[16:19], v[76:79], v[96:99]
    ds_read_b64 v[66:67], v1 offset:14336
    v_add_u32 v4, 0xffffb000, v4
    v_mfma_f32_16x16x32_bf16 v[100:103], v[20:23], v[76:79], v[100:103]
    s_cselect_b32 s62, s58, s62
    s_waitcnt lgkmcnt(10)
    v_mfma_f32_16x16x32_bf16 v[104:107], v[16:19], v[80:83], v[104:107]
    v_mfma_f32_16x16x32_bf16 v[108:111], v[20:23], v[80:83], v[108:111]
    ds_read_b64 v[68:69], v1 offset:6144
    ds_read_b64 v[70:71], v1 offset:16384
    v_mfma_f32_16x16x32_bf16 v[112:115], v[16:19], v[84:87], v[112:115]
    buffer_load_dwordx4 v[8:11], v7, s[48:51], s62 offen offset:0 sc1
    ds_read_b64 v[72:73], v1 offset:8192
    v_mfma_f32_16x16x32_bf16 v[116:119], v[20:23], v[84:87], v[116:119]
    ds_read_b64 v[74:75], v1 offset:18432
    s_waitcnt lgkmcnt(10)
    v_mfma_f32_16x16x32_bf16 v[120:123], v[16:19], v[88:91], v[120:123]
    ds_read_b64 v[76:77], v2 offset:0
    v_mfma_f32_16x16x32_bf16 v[124:127], v[20:23], v[88:91], v[124:127]
    ds_read_b64 v[78:79], v2 offset:10240
    buffer_load_dwordx4 v[12:15], v7, s[48:51], s62 offen offset:1024 sc1
    v_mfma_f32_16x16x32_bf16 v[128:131], v[16:19], v[92:95], v[128:131]
    ds_read_b64 v[80:81], v2 offset:2048
    ds_read_b64 v[82:83], v2 offset:12288
    v_mfma_f32_16x16x32_bf16 v[132:135], v[20:23], v[92:95], v[132:135]
    s_waitcnt vmcnt(8)
    s_waitcnt lgkmcnt(10)
    v_mfma_f32_16x16x32_bf16 v[96:99], v[24:27], v[56:59], v[96:99]
    v_mfma_f32_16x16x32_bf16 v[100:103], v[28:31], v[56:59], v[100:103]
    ds_read_b64 v[84:85], v2 offset:4096
    ds_read_b64 v[86:87], v2 offset:14336
    v_mfma_f32_16x16x32_bf16 v[104:107], v[24:27], v[60:63], v[104:107]
    ds_read_b64 v[88:89], v2 offset:6144
    ds_read_b64 v[90:91], v2 offset:16384
    v_mfma_f32_16x16x32_bf16 v[108:111], v[28:31], v[60:63], v[108:111]
    buffer_load_dwordx4 v[16:19], v7, s[48:51], s62 offen offset:2048 sc1
    s_waitcnt lgkmcnt(10)
    v_mfma_f32_16x16x32_bf16 v[112:115], v[24:27], v[64:67], v[112:115]
    v_mfma_f32_16x16x32_bf16 v[116:119], v[28:31], v[64:67], v[116:119]
    ds_read_b64 v[92:93], v2 offset:8192
    ds_read_b64 v[94:95], v2 offset:18432
    v_mfma_f32_16x16x32_bf16 v[120:123], v[24:27], v[68:71], v[120:123]
    ds_read_b64 v[56:57], v3 offset:0
    ds_read_b64 v[58:59], v3 offset:10240
    v_mfma_f32_16x16x32_bf16 v[124:127], v[28:31], v[68:71], v[124:127]
    buffer_load_dwordx4 v[20:23], v7, s[48:51], s62 offen offset:3072 sc1
    s_waitcnt lgkmcnt(10)
    v_mfma_f32_16x16x32_bf16 v[128:131], v[24:27], v[72:75], v[128:131]
    ds_read_b64 v[60:61], v3 offset:2048
    ds_read_b64 v[62:63], v3 offset:12288
    v_mfma_f32_16x16x32_bf16 v[132:135], v[28:31], v[72:75], v[132:135]
    v_add_u32 v1, 0xffffb000, v1
    s_waitcnt vmcnt(8)
    v_mfma_f32_16x16x32_bf16 v[96:99], v[32:35], v[76:79], v[96:99]
    ds_read_b64 v[64:65], v3 offset:4096
    ds_read_b64 v[66:67], v3 offset:14336
    v_mfma_f32_16x16x32_bf16 v[100:103], v[36:39], v[76:79], v[100:103]
    v_add_u32 v2, 0xffffb000, v2
    s_waitcnt lgkmcnt(10)
    v_mfma_f32_16x16x32_bf16 v[104:107], v[32:35], v[80:83], v[104:107]
    ds_read_b64 v[68:69], v3 offset:6144
    v_mfma_f32_16x16x32_bf16 v[108:111], v[36:39], v[80:83], v[108:111]
    ds_read_b64 v[70:71], v3 offset:16384
    buffer_load_dwordx4 v[24:27], v6, s[48:51], s62 offen offset:0 sc1
    v_mfma_f32_16x16x32_bf16 v[112:115], v[32:35], v[84:87], v[112:115]
    ds_read_b64 v[72:73], v3 offset:8192
    ds_read_b64 v[74:75], v3 offset:18432
    v_mfma_f32_16x16x32_bf16 v[116:119], v[36:39], v[84:87], v[116:119]
    s_add_u32 s65, s65, 1
    s_waitcnt lgkmcnt(10)
    v_mfma_f32_16x16x32_bf16 v[120:123], v[32:35], v[88:91], v[120:123]
    ds_read_b64 v[76:77], v4 offset:0
    v_mfma_f32_16x16x32_bf16 v[124:127], v[36:39], v[88:91], v[124:127]
    ds_read_b64 v[78:79], v4 offset:10240
    buffer_load_dwordx4 v[28:31], v6, s[48:51], s62 offen offset:1024 sc1
    v_mfma_f32_16x16x32_bf16 v[128:131], v[32:35], v[92:95], v[128:131]
    ds_read_b64 v[80:81], v4 offset:2048
    ds_read_b64 v[82:83], v4 offset:12288
    v_mfma_f32_16x16x32_bf16 v[132:135], v[36:39], v[92:95], v[132:135]
    s_waitcnt vmcnt(8)
    s_waitcnt lgkmcnt(10)
    v_mfma_f32_16x16x32_bf16 v[96:99], v[40:43], v[56:59], v[96:99]
    ds_read_b64 v[84:85], v4 offset:4096
    v_mfma_f32_16x16x32_bf16 v[100:103], v[44:47], v[56:59], v[100:103]
    ds_read_b64 v[86:87], v4 offset:14336
    v_add_u32 v3, 0xffffb000, v3
    v_mfma_f32_16x16x32_bf16 v[104:107], v[40:43], v[60:63], v[104:107]
    ds_read_b64 v[88:89], v4 offset:6144
    ds_read_b64 v[90:91], v4 offset:16384
    v_mfma_f32_16x16x32_bf16 v[108:111], v[44:47], v[60:63], v[108:111]
    buffer_load_dwordx4 v[32:35], v6, s[48:51], s62 offen offset:2048 sc1
    s_waitcnt lgkmcnt(10)
    v_mfma_f32_16x16x32_bf16 v[112:115], v[40:43], v[64:67], v[112:115]
    ds_read_b64 v[92:93], v4 offset:8192
    ds_read_b64 v[94:95], v4 offset:18432
    v_mfma_f32_16x16x32_bf16 v[116:119], v[44:47], v[64:67], v[116:119]
    ds_read_b64 v[56:57], v1 offset:0
    ds_read_b64 v[58:59], v1 offset:10240
    v_mfma_f32_16x16x32_bf16 v[120:123], v[40:43], v[68:71], v[120:123]
    buffer_load_dwordx4 v[36:39], v6, s[48:51], s62 offen offset:3072 sc1
    s_waitcnt lgkmcnt(10)
    v_mfma_f32_16x16x32_bf16 v[124:127], v[44:47], v[68:71], v[124:127]
    ds_read_b64 v[60:61], v1 offset:2048
    ds_read_b64 v[62:63], v1 offset:12288
    v_mfma_f32_16x16x32_bf16 v[128:131], v[40:43], v[72:75], v[128:131]
    s_add_u32 s62, s62, s57
    s_cmp_eq_u32 s62, s61
    v_mfma_f32_16x16x32_bf16 v[132:135], v[44:47], v[72:75], v[132:135]
    s_waitcnt vmcnt(8)
    ds_read_b64 v[64:65], v1 offset:4096
    v_mfma_f32_16x16x32_bf16 v[96:99], v[48:51], v[76:79], v[96:99]
    ds_read_b64 v[66:67], v1 offset:14336
    v_add_u32 v4, 0xffffb000, v4
    v_mfma_f32_16x16x32_bf16 v[100:103], v[52:55], v[76:79], v[100:103]
    s_cselect_b32 s62, s58, s62
    s_waitcnt lgkmcnt(10)
    v_mfma_f32_16x16x32_bf16 v[104:107], v[48:51], v[80:83], v[104:107]
    ds_read_b64 v[68:69], v1 offset:6144
    v_mfma_f32_16x16x32_bf16 v[108:111], v[52:55], v[80:83], v[108:111]
    ds_read_b64 v[70:71], v1 offset:16384
    buffer_load_dwordx4 v[40:43], v7, s[48:51], s62 offen offset:0 sc1
    v_mfma_f32_16x16x32_bf16 v[112:115], v[48:51], v[84:87], v[112:115]
    ds_read_b64 v[72:73], v1 offset:8192
    ds_read_b64 v[74:75], v1 offset:18432
    v_mfma_f32_16x16x32_bf16 v[116:119], v[52:55], v[84:87], v[116:119]
    s_cmp_lt_u32 s65, 2
    s_waitcnt lgkmcnt(10)
    v_mfma_f32_16x16x32_bf16 v[120:123], v[48:51], v[88:91], v[120:123]
    ds_read_b64 v[76:77], v2 offset:0
    v_mfma_f32_16x16x32_bf16 v[124:127], v[52:55], v[88:91], v[124:127]
    ds_read_b64 v[78:79], v2 offset:10240
    buffer_load_dwordx4 v[44:47], v7, s[48:51], s62 offen offset:1024 sc1
    v_mfma_f32_16x16x32_bf16 v[128:131], v[48:51], v[92:95], v[128:131]
    ds_read_b64 v[80:81], v2 offset:2048
    ds_read_b64 v[82:83], v2 offset:12288
    v_mfma_f32_16x16x32_bf16 v[132:135], v[52:55], v[92:95], v[132:135]
    s_cbranch_scc1 L_bp2_60
    s_waitcnt vmcnt(8)
    s_waitcnt lgkmcnt(10)
    v_mfma_f32_16x16x32_bf16 v[96:99], v[8:11], v[56:59], v[96:99]
    v_mfma_f32_16x16x32_bf16 v[100:103], v[12:15], v[56:59], v[100:103]
    ds_read_b64 v[84:85], v2 offset:4096
    ds_read_b64 v[86:87], v2 offset:14336
    v_mfma_f32_16x16x32_bf16 v[104:107], v[8:11], v[60:63], v[104:107]
    ds_read_b64 v[88:89], v2 offset:6144
    ds_read_b64 v[90:91], v2 offset:16384
    v_mfma_f32_16x16x32_bf16 v[108:111], v[12:15], v[60:63], v[108:111]
    buffer_load_dwordx4 v[48:51], v7, s[48:51], s62 offen offset:2048 sc1
    s_waitcnt lgkmcnt(10)
    v_mfma_f32_16x16x32_bf16 v[112:115], v[8:11], v[64:67], v[112:115]
    v_mfma_f32_16x16x32_bf16 v[116:119], v[12:15], v[64:67], v[116:119]
    ds_read_b64 v[92:93], v2 offset:8192
    ds_read_b64 v[94:95], v2 offset:18432
    v_mfma_f32_16x16x32_bf16 v[120:123], v[8:11], v[68:71], v[120:123]
    ds_read_b64 v[56:57], v3 offset:0
    ds_read_b64 v[58:59], v3 offset:10240
    v_mfma_f32_16x16x32_bf16 v[124:127], v[12:15], v[68:71], v[124:127]
    buffer_load_dwordx4 v[52:55], v7, s[48:51], s62 offen offset:3072 sc1
    s_waitcnt lgkmcnt(10)
    v_mfma_f32_16x16x32_bf16 v[128:131], v[8:11], v[72:75], v[128:131]
    ds_read_b64 v[60:61], v3 offset:2048
    ds_read_b64 v[62:63], v3 offset:12288
    v_mfma_f32_16x16x32_bf16 v[132:135], v[12:15], v[72:75], v[132:135]
    v_add_u32 v1, 143360, v1
    s_waitcnt vmcnt(8)
    v_mfma_f32_16x16x32_bf16 v[96:99], v[16:19], v[76:79], v[96:99]
    ds_read_b64 v[64:65], v3 offset:4096
    ds_read_b64 v[66:67], v3 offset:14336
    v_mfma_f32_16x16x32_bf16 v[100:103], v[20:23], v[76:79], v[100:103]
    v_add_u32 v2, 143360, v2
    s_waitcnt lgkmcnt(10)
    v_mfma_f32_16x16x32_bf16 v[104:107], v[16:19], v[80:83], v[104:107]
    ds_read_b64 v[68:69], v3 offset:6144
    v_mfma_f32_16x16x32_bf16 v[108:111], v[20:23], v[80:83], v[108:111]
    ds_read_b64 v[70:71], v3 offset:16384
    buffer_load_dwordx4 v[8:11], v6, s[48:51], s62 offen offset:0 sc1
    v_mfma_f32_16x16x32_bf16 v[112:115], v[16:19], v[84:87], v[112:115]
    ds_read_b64 v[72:73], v3 offset:8192
    ds_read_b64 v[74:75], v3 offset:18432
    v_mfma_f32_16x16x32_bf16 v[116:119], v[20:23], v[84:87], v[116:119]
    s_waitcnt lgkmcnt(10)
    ds_read_b64 v[76:77], v4 offset:0
    v_mfma_f32_16x16x32_bf16 v[120:123], v[16:19], v[88:91], v[120:123]
    ds_read_b64 v[78:79], v4 offset:10240
    buffer_load_dwordx4 v[12:15], v6, s[48:51], s62 offen offset:1024 sc1
    v_mfma_f32_16x16x32_bf16 v[124:127], v[20:23], v[88:91], v[124:127]
    ds_read_b64 v[80:81], v4 offset:2048
    ds_read_b64 v[82:83], v4 offset:12288
    v_mfma_f32_16x16x32_bf16 v[128:131], v[16:19], v[92:95], v[128:131]
    s_waitcnt vmcnt(8)
    s_waitcnt lgkmcnt(10)
    v_mfma_f32_16x16x32_bf16 v[132:135], v[20:23], v[92:95], v[132:135]
    ds_read_b64 v[84:85], v4 offset:4096
    ds_read_b64 v[86:87], v4 offset:14336
    v_mfma_f32_16x16x32_bf16 v[96:99], v[24:27], v[56:59], v[96:99]
    v_add_u32 v3, 143360, v3
    ds_read_b64 v[88:89], v4 offset:6144
    v_mfma_f32_16x16x32_bf16 v[100:103], v[28:31], v[56:59], v[100:103]
    ds_read_b64 v[90:91], v4 offset:16384
    buffer_load_dwordx4 v[16:19], v6, s[48:51], s62 offen offset:2048 sc1
    v_mfma_f32_16x16x32_bf16 v[104:107], v[24:27], v[60:63], v[104:107]
    s_waitcnt lgkmcnt(10)
    ds_read_b64 v[92:93], v4 offset:8192
    v_mfma_f32_16x16x32_bf16 v[108:111], v[28:31], v[60:63], v[108:111]
    ds_read_b64 v[94:95], v4 offset:18432
    ds_read_b64 v[56:57], v1 offset:0
    v_mfma_f32_16x16x32_bf16 v[112:115], v[24:27], v[64:67], v[112:115]
    ds_read_b64 v[58:59], v1 offset:10240
    buffer_load_dwordx4 v[20:23], v6, s[48:51], s62 offen offset:3072 sc1
    v_mfma_f32_16x16x32_bf16 v[116:119], v[28:31], v[64:67], v[116:119]
    s_waitcnt lgkmcnt(10)
    ds_read_b64 v[60:61], v1 offset:2048
    v_mfma_f32_16x16x32_bf16 v[120:123], v[24:27], v[68:71], v[120:123]
    ds_read_b64 v[62:63], v1 offset:12288
    s_add_u32 s62, s62, s57
    v_mfma_f32_16x16x32_bf16 v[124:127], v[28:31], v[68:71], v[124:127]
    s_cmp_eq_u32 s62, s61
    s_waitcnt vmcnt(8)
    v_mfma_f32_16x16x32_bf16 v[128:131], v[24:27], v[72:75], v[128:131]
    ds_read_b64 v[64:65], v1 offset:4096
    ds_read_b64 v[66:67], v1 offset:14336
    v_mfma_f32_16x16x32_bf16 v[132:135], v[28:31], v[72:75], v[132:135]
    v_add_u32 v4, 143360, v4
    s_cselect_b32 s62, s58, s62
    v_mfma_f32_16x16x32_bf16 v[96:99], v[32:35], v[76:79], v[96:99]
    s_add_u32 s62, s62, s70
    s_cmp_eq_u32 s62, s61
    v_mfma_f32_16x16x32_bf16 v[100:103], v[36:39], v[76:79], v[100:103]
    s_cselect_b32 s62, s58, s62
    s_waitcnt lgkmcnt(10)
    v_mfma_f32_16x16x32_bf16 v[104:107], v[32:35], v[80:83], v[104:107]
    v_mfma_f32_16x16x32_bf16 v[108:111], v[36:39], v[80:83], v[108:111]
    ds_read_b64 v[68:69], v1 offset:6144
    ds_read_b64 v[70:71], v1 offset:16384
    v_mfma_f32_16x16x32_bf16 v[112:115], v[32:35], v[84:87], v[112:115]
    buffer_load_dwordx4 v[24:27], v7, s[48:51], s62 offen offset:0 sc1
    ds_read_b64 v[72:73], v1 offset:8192
    v_mfma_f32_16x16x32_bf16 v[116:119], v[36:39], v[84:87], v[116:119]
    ds_read_b64 v[74:75], v1 offset:18432
    s_waitcnt lgkmcnt(10)
    v_mfma_f32_16x16x32_bf16 v[120:123], v[32:35], v[88:91], v[120:123]
    ds_read_b64 v[76:77], v2 offset:0
    v_mfma_f32_16x16x32_bf16 v[124:127], v[36:39], v[88:91], v[124:127]
    ds_read_b64 v[78:79], v2 offset:10240
    buffer_load_dwordx4 v[28:31], v7, s[48:51], s62 offen offset:1024 sc1
    v_mfma_f32_16x16x32_bf16 v[128:131], v[32:35], v[92:95], v[128:131]
    ds_read_b64 v[80:81], v2 offset:2048
    ds_read_b64 v[82:83], v2 offset:12288
    v_mfma_f32_16x16x32_bf16 v[132:135], v[36:39], v[92:95], v[132:135]
    s_waitcnt vmcnt(8)
    s_waitcnt lgkmcnt(10)
    v_mfma_f32_16x16x32_bf16 v[96:99], v[40:43], v[56:59], v[96:99]
    v_mfma_f32_16x16x32_bf16 v[100:103], v[44:47], v[56:59], v[100:103]
    ds_read_b64 v[84:85], v2 offset:4096
    ds_read_b64 v[86:87], v2 offset:14336
    v_mfma_f32_16x16x32_bf16 v[104:107], v[40:43], v[60:63], v[104:107]
    ds_read_b64 v[88:89], v2 offset:6144
    ds_read_b64 v[90:91], v2 offset:16384
    v_mfma_f32_16x16x32_bf16 v[108:111], v[44:47], v[60:63], v[108:111]
    buffer_load_dwordx4 v[32:35], v7, s[48:51], s62 offen offset:2048 sc1
    s_waitcnt lgkmcnt(10)
    v_mfma_f32_16x16x32_bf16 v[112:115], v[40:43], v[64:67], v[112:115]
    v_mfma_f32_16x16x32_bf16 v[116:119], v[44:47], v[64:67], v[116:119]
    ds_read_b64 v[92:93], v2 offset:8192
    ds_read_b64 v[94:95], v2 offset:18432
    v_mfma_f32_16x16x32_bf16 v[120:123], v[40:43], v[68:71], v[120:123]
    ds_read_b64 v[56:57], v3 offset:0
    ds_read_b64 v[58:59], v3 offset:10240
    v_mfma_f32_16x16x32_bf16 v[124:127], v[44:47], v[68:71], v[124:127]
    buffer_load_dwordx4 v[36:39], v7, s[48:51], s62 offen offset:3072 sc1
    s_waitcnt lgkmcnt(10)
    v_mfma_f32_16x16x32_bf16 v[128:131], v[40:43], v[72:75], v[128:131]
    ds_read_b64 v[60:61], v3 offset:2048
    ds_read_b64 v[62:63], v3 offset:12288
    v_mfma_f32_16x16x32_bf16 v[132:135], v[44:47], v[72:75], v[132:135]
    v_add_u32 v1, 0xffffb000, v1
    s_waitcnt vmcnt(8)
    v_mfma_f32_16x16x32_bf16 v[96:99], v[48:51], v[76:79], v[96:99]
    ds_read_b64 v[64:65], v3 offset:4096
    ds_read_b64 v[66:67], v3 offset:14336
    v_mfma_f32_16x16x32_bf16 v[100:103], v[52:55], v[76:79], v[100:103]
    v_add_u32 v2, 0xffffb000, v2
    s_waitcnt lgkmcnt(10)
    v_mfma_f32_16x16x32_bf16 v[104:107], v[48:51], v[80:83], v[104:107]
    v_mfma_f32_16x16x32_bf16 v[108:111], v[52:55], v[80:83], v[108:111]
    ds_read_b64 v[68:69], v3 offset:6144
    ds_read_b64 v[70:71], v3 offset:16384
    v_mfma_f32_16x16x32_bf16 v[112:115], v[48:51], v[84:87], v[112:115]
    buffer_load_dwordx4 v[40:43], v6, s[48:51], s62 offen offset:0 sc1
    ds_read_b64 v[72:73], v3 offset:8192
    v_mfma_f32_16x16x32_bf16 v[116:119], v[52:55], v[84:87], v[116:119]
    ds_read_b64 v[74:75], v3 offset:18432
    s_waitcnt lgkmcnt(10)
    v_mfma_f32_16x16x32_bf16 v[120:123], v[48:51], v[88:91], v[120:123]
    ds_read_b64 v[76:77], v4 offset:0
    v_mfma_f32_16x16x32_bf16 v[124:127], v[52:55], v[88:91], v[124:127]
    ds_read_b64 v[78:79], v4 offset:10240
    buffer_load_dwordx4 v[44:47], v6, s[48:51], s62 offen offset:1024 sc1
    v_mfma_f32_16x16x32_bf16 v[128:131], v[48:51], v[92:95], v[128:131]
    ds_read_b64 v[80:81], v4 offset:2048
    ds_read_b64 v[82:83], v4 offset:12288
    v_mfma_f32_16x16x32_bf16 v[132:135], v[52:55], v[92:95], v[132:135]
    s_waitcnt vmcnt(8)
    s_waitcnt lgkmcnt(10)
    v_mfma_f32_16x16x32_bf16 v[96:99], v[8:11], v[56:59], v[96:99]
    ds_read_b64 v[84:85], v4 offset:4096
    ds_read_b64 v[86:87], v4 offset:14336
    v_mfma_f32_16x16x32_bf16 v[100:103], v[12:15], v[56:59], v[100:103]
    buffer_load_dwordx4 v[48:51], v6, s[48:51], s62 offen offset:2048 sc1
    v_add_u32 v3, 0xffffb000, v3
    v_mfma_f32_16x16x32_bf16 v[104:107], v[8:11], v[60:63], v[104:107]
    ds_read_b64 v[88:89], v4 offset:6144
    ds_read_b64 v[90:91], v4 offset:16384
    v_mfma_f32_16x16x32_bf16 v[108:111], v[12:15], v[60:63], v[108:111]
    buffer_load_dwordx4 v[52:55], v6, s[48:51], s62 offen offset:3072 sc1
    s_waitcnt lgkmcnt(10)
    v_mfma_f32_16x16x32_bf16 v[112:115], v[8:11], v[64:67], v[112:115]
    v_mfma_f32_16x16x32_bf16 v[116:119], v[12:15], v[64:67], v[116:119]
    ds_read_b64 v[92:93], v4 offset:8192
    ds_read_b64 v[94:95], v4 offset:18432
    v_mfma_f32_16x16x32_bf16 v[120:123], v[8:11], v[68:71], v[120:123]
    ds_read_b64 v[56:57], v1 offset:0
    ds_read_b64 v[58:59], v1 offset:10240
    v_mfma_f32_16x16x32_bf16 v[124:127], v[12:15], v[68:71], v[124:127]
    v_add_u32 v4, 0xffffb000, v4
    s_waitcnt lgkmcnt(10)
    v_mfma_f32_16x16x32_bf16 v[128:131], v[8:11], v[72:75], v[128:131]
    ds_read_b64 v[60:61], v2 offset:0
    v_mfma_f32_16x16x32_bf16 v[132:135], v[12:15], v[72:75], v[132:135]
    ds_read_b64 v[62:63], v2 offset:10240
    s_waitcnt vmcnt(8)
    v_mfma_f32_16x16x32_bf16 v[96:99], v[16:19], v[76:79], v[96:99]
    ds_read_b64 v[64:65], v3 offset:0
    v_mfma_f32_16x16x32_bf16 v[100:103], v[20:23], v[76:79], v[100:103]
    ds_read_b64 v[66:67], v3 offset:10240
    s_waitcnt lgkmcnt(10)
    v_mfma_f32_16x16x32_bf16 v[104:107], v[16:19], v[80:83], v[104:107]
    v_mfma_f32_16x16x32_bf16 v[108:111], v[20:23], v[80:83], v[108:111]
    ds_read_b64 v[68:69], v4 offset:0
    ds_read_b64 v[70:71], v4 offset:10240
    v_mfma_f32_16x16x32_bf16 v[112:115], v[16:19], v[84:87], v[112:115]
    ds_read_b64 v[72:73], v1 offset:2048
    v_mfma_f32_16x16x32_bf16 v[116:119], v[20:23], v[84:87], v[116:119]
    ds_read_b64 v[74:75], v1 offset:12288
    s_waitcnt lgkmcnt(10)
    v_mfma_f32_16x16x32_bf16 v[120:123], v[16:19], v[88:91], v[120:123]
    ds_read_b64 v[76:77], v2 offset:2048
    v_mfma_f32_16x16x32_bf16 v[124:127], v[20:23], v[88:91], v[124:127]
    ds_read_b64 v[78:79], v2 offset:12288
    ds_read_b64 v[80:81], v3 offset:2048
    v_mfma_f32_16x16x32_bf16 v[128:131], v[16:19], v[92:95], v[128:131]
    ds_read_b64 v[82:83], v3 offset:12288
    s_waitcnt vmcnt(6)
    v_mfma_f32_16x16x32_bf16 v[132:135], v[20:23], v[92:95], v[132:135]
    s_waitcnt lgkmcnt(10)
    ds_read_b64 v[84:85], v4 offset:2048
    v_mfma_f32_16x16x32_bf16 v[96:99], v[24:27], v[56:59], v[96:99]
    ds_read_b64 v[86:87], v4 offset:12288
    s_waitcnt vmcnt(4)
    v_mfma_f32_16x16x32_bf16 v[100:103], v[28:31], v[56:59], v[100:103]
    ds_read_b64 v[88:89], v1 offset:4096
    ds_read_b64 v[90:91], v1 offset:14336
    v_mfma_f32_16x16x32_bf16 v[96:99], v[32:35], v[60:63], v[96:99]
    s_waitcnt vmcnt(2)
    s_waitcnt lgkmcnt(10)
    v_mfma_f32_16x16x32_bf16 v[100:103], v[36:39], v[60:63], v[100:103]
    ds_read_b64 v[92:93], v2 offset:4096
    ds_read_b64 v[94:95], v2 offset:14336
    v_mfma_f32_16x16x32_bf16 v[96:99], v[40:43], v[64:67], v[96:99]
    s_waitcnt vmcnt(0)
    ds_read_b64 v[56:57], v3 offset:4096
    v_mfma_f32_16x16x32_bf16 v[100:103], v[44:47], v[64:67], v[100:103]
    ds_read_b64 v[58:59], v3 offset:14336
    s_waitcnt lgkmcnt(10)
    v_mfma_f32_16x16x32_bf16 v[96:99], v[48:51], v[68:71], v[96:99]
    ds_read_b64 v[60:61], v4 offset:4096
    ds_read_b64 v[62:63], v4 offset:14336
    v_mfma_f32_16x16x32_bf16 v[100:103], v[52:55], v[68:71], v[100:103]
    ds_read_b64 v[64:65], v1 offset:6144
    ds_read_b64 v[66:67], v1 offset:16384
    v_mfma_f32_16x16x32_bf16 v[104:107], v[24:27], v[72:75], v[104:107]
    s_nop 1
    buffer_store_dword v96, v140, s[44:47], s94 offen offset:0 sc1
    buffer_store_dword v97, v140, s[44:47], s95 offen offset:0 sc1
    v_mfma_f32_16x16x32_bf16 v[108:111], v[28:31], v[72:75], v[108:111]
    buffer_store_dword v98, v140, s[44:47], s96 offen offset:0 sc1
    s_waitcnt lgkmcnt(10)
    v_mfma_f32_16x16x32_bf16 v[104:107], v[32:35], v[76:79], v[104:107]
    ds_read_b64 v[68:69], v2 offset:6144
    ds_read_b64 v[70:71], v2 offset:16384
    v_mfma_f32_16x16x32_bf16 v[108:111], v[36:39], v[76:79], v[108:111]
    buffer_store_dword v99, v140, s[44:47], s97 offen offset:0 sc1
    buffer_store_dword v100, v140, s[44:47], s98 offen offset:0 sc1
    v_mfma_f32_16x16x32_bf16 v[104:107], v[40:43], v[80:83], v[104:107]
    buffer_store_dword v101, v140, s[44:47], s99 offen offset:0 sc1
    ds_read_b64 v[72:73], v3 offset:6144
    v_mfma_f32_16x16x32_bf16 v[108:111], v[44:47], v[80:83], v[108:111]
    ds_read_b64 v[74:75], v3 offset:16384
    buffer_store_dword v102, v140, s[44:47], s100 offen offset:0 sc1
    v_mfma_f32_16x16x32_bf16 v[104:107], v[48:51], v[84:87], v[104:107]
    buffer_store_dword v103, v140, s[44:47], s101 offen offset:0 sc1
    s_waitcnt lgkmcnt(10)
    v_mfma_f32_16x16x32_bf16 v[108:111], v[52:55], v[84:87], v[108:111]
    ds_read_b64 v[76:77], v4 offset:6144
    ds_read_b64 v[78:79], v4 offset:16384
    v_mfma_f32_16x16x32_bf16 v[112:115], v[24:27], v[88:91], v[112:115]
    ds_read_b64 v[80:81], v1 offset:8192
    ds_read_b64 v[82:83], v1 offset:18432
    v_mfma_f32_16x16x32_bf16 v[116:119], v[28:31], v[88:91], v[116:119]
    buffer_store_dword v104, v140, s[44:47], s94 offen offset:64 sc1
    buffer_store_dword v105, v140, s[44:47], s95 offen offset:64 sc1
    v_mfma_f32_16x16x32_bf16 v[112:115], v[32:35], v[92:95], v[112:115]
    buffer_store_dword v106, v140, s[44:47], s96 offen offset:64 sc1
    s_waitcnt lgkmcnt(10)
    v_mfma_f32_16x16x32_bf16 v[116:119], v[36:39], v[92:95], v[116:119]
    ds_read_b64 v[84:85], v2 offset:8192
    ds_read_b64 v[86:87], v2 offset:18432
    v_mfma_f32_16x16x32_bf16 v[112:115], v[40:43], v[56:59], v[112:115]
    buffer_store_dword v107, v140, s[44:47], s97 offen offset:64 sc1
    buffer_store_dword v108, v140, s[44:47], s98 offen offset:64 sc1
    v_mfma_f32_16x16x32_bf16 v[116:119], v[44:47], v[56:59], v[116:119]
    buffer_store_dword v109, v140, s[44:47], s99 offen offset:64 sc1
    ds_read_b64 v[88:89], v3 offset:8192
    v_mfma_f32_16x16x32_bf16 v[112:115], v[48:51], v[60:63], v[112:115]
    ds_read_b64 v[90:91], v3 offset:18432
    buffer_store_dword v110, v140, s[44:47], s100 offen offset:64 sc1
    v_mfma_f32_16x16x32_bf16 v[116:119], v[52:55], v[60:63], v[116:119]
    buffer_store_dword v111, v140, s[44:47], s101 offen offset:64 sc1
    s_waitcnt lgkmcnt(10)
    v_mfma_f32_16x16x32_bf16 v[120:123], v[24:27], v[64:67], v[120:123]
    v_mfma_f32_16x16x32_bf16 v[124:127], v[28:31], v[64:67], v[124:127]
    ds_read_b64 v[92:93], v4 offset:8192
    ds_read_b64 v[94:95], v4 offset:18432
    v_mfma_f32_16x16x32_bf16 v[120:123], v[32:35], v[68:71], v[120:123]
    buffer_store_dword v112, v140, s[44:47], s94 offen offset:128 sc1
    buffer_store_dword v113, v140, s[44:47], s95 offen offset:128 sc1
    v_mfma_f32_16x16x32_bf16 v[124:127], v[36:39], v[68:71], v[124:127]
    buffer_store_dword v114, v140, s[44:47], s96 offen offset:128 sc1
    s_waitcnt lgkmcnt(8)
    v_mfma_f32_16x16x32_bf16 v[120:123], v[40:43], v[72:75], v[120:123]
    v_mfma_f32_16x16x32_bf16 v[124:127], v[44:47], v[72:75], v[124:127]
    buffer_store_dword v115, v140, s[44:47], s97 offen offset:128 sc1
    buffer_store_dword v116, v140, s[44:47], s98 offen offset:128 sc1
    v_mfma_f32_16x16x32_bf16 v[120:123], v[48:51], v[76:79], v[120:123]
    buffer_store_dword v117, v140, s[44:47], s99 offen offset:128 sc1
    buffer_store_dword v118, v140, s[44:47], s100 offen offset:128 sc1
    v_mfma_f32_16x16x32_bf16 v[124:127], v[52:55], v[76:79], v[124:127]
    buffer_store_dword v119, v140, s[44:47], s101 offen offset:128 sc1
    s_waitcnt lgkmcnt(4)
    v_mfma_f32_16x16x32_bf16 v[128:131], v[24:27], v[80:83], v[128:131]
    v_mfma_f32_16x16x32_bf16 v[132:135], v[28:31], v[80:83], v[132:135]
    v_mfma_f32_16x16x32_bf16 v[128:131], v[32:35], v[84:87], v[128:131]
    buffer_store_dword v120, v140, s[44:47], s94 offen offset:192 sc1
    buffer_store_dword v121, v140, s[44:47], s95 offen offset:192 sc1
    v_mfma_f32_16x16x32_bf16 v[132:135], v[36:39], v[84:87], v[132:135]
    buffer_store_dword v122, v140, s[44:47], s96 offen offset:192 sc1
    s_waitcnt lgkmcnt(0)
    v_mfma_f32_16x16x32_bf16 v[128:131], v[40:43], v[88:91], v[128:131]
    buffer_store_dword v123, v140, s[44:47], s97 offen offset:192 sc1
    v_mfma_f32_16x16x32_bf16 v[132:135], v[44:47], v[88:91], v[132:135]
    buffer_store_dword v124, v140, s[44:47], s98 offen offset:192 sc1
    buffer_store_dword v125, v140, s[44:47], s99 offen offset:192 sc1
    v_mfma_f32_16x16x32_bf16 v[128:131], v[48:51], v[92:95], v[128:131]
    buffer_store_dword v126, v140, s[44:47], s100 offen offset:192 sc1
    buffer_store_dword v127, v140, s[44:47], s101 offen offset:192 sc1
    v_mfma_f32_16x16x32_bf16 v[132:135], v[52:55], v[92:95], v[132:135]
    s_nop 4
    buffer_store_dword v128, v140, s[44:47], s94 offen offset:256 sc1
    buffer_store_dword v129, v140, s[44:47], s95 offen offset:256 sc1
    buffer_store_dword v130, v140, s[44:47], s96 offen offset:256 sc1
    buffer_store_dword v131, v140, s[44:47], s97 offen offset:256 sc1
    buffer_store_dword v132, v140, s[44:47], s98 offen offset:256 sc1
    buffer_store_dword v133, v140, s[44:47], s99 offen offset:256 sc1
    buffer_store_dword v134, v140, s[44:47], s100 offen offset:256 sc1
    buffer_store_dword v135, v140, s[44:47], s101 offen offset:256 sc1
    s_or_b32 s59, s53, s55
    s_cmp_lg_u32 s59, 0
    s_cbranch_scc1 L_noep_61
    s_cmp_lg_u32 s52, 15
    s_cbranch_scc1 L_noep_61
    s_lshl_b32 s59, s35, 8
    v_mov_b32 v250, s56
    v_mov_b32 v251, 0
    s_mov_b64 exec, 1
    buffer_store_dword v250, v251, s[48:51], s59 offen sc1
    s_mov_b64 exec, -1
L_noep_61:
    s_endpgm
L_END:
    s_endpgm
.section .rodata,"a"
.p2align 6
.amdhsa_kernel concat_heads__linear_attn_block__ssm_conv_s5__prompt_kernel
  .amdhsa_next_free_vgpr 256
  .amdhsa_next_free_sgpr 102
  .amdhsa_accum_offset 256
  .amdhsa_group_segment_fixed_size 0
  .amdhsa_kernarg_size 120
  .amdhsa_user_sgpr_count 2
  .amdhsa_user_sgpr_kernarg_segment_ptr 1
  .amdhsa_system_sgpr_workgroup_id_x 1
.end_amdhsa_kernel
```
